```python
import torch

def _softmax(x, axis=-1):
    return torch.softmax(x, dim=axis)
def _gelu(x):
    return torch.nn.functional.gelu(x, approximate="tanh")
def _silu(x):
    return torch.nn.functional.silu(x)
def _sigmoid(x):
    return torch.sigmoid(x)
def _layernorm(x, axis=-1, eps=1e-5):
    m = x.mean(dim=axis, keepdim=True)
    v = x.var(dim=axis, keepdim=True, unbiased=False)
    return (x - m) / torch.sqrt(v + eps)
def _scatter_add(tgt, idx, src, axis=0):
    return tgt.clone().index_add_(axis, idx, src)
def _segment_sum(src, seg, n):
    out = torch.zeros((n,) + src.shape[1:], dtype=src.dtype)
    return out.index_add_(0, seg, src)
def _pad(x, pw):
    flat = tuple(v for pair in reversed(pw) for v in pair)
    return torch.nn.functional.pad(x, flat)

kernel_name = 'standalone__batchnorm__sampling'

def setup_inputs():

    _w = (lambda a: (lambda t: t.to(torch.bfloat16) if t.is_floating_point() else t)(torch.as_tensor(a)))
    B, S, C = 1024, 16, 512
    K = 3
    return {
        "x": _w((lambda *s: torch.randn(*s, dtype=torch.bfloat16) * 0.05)(B, S, C)),
        "w": _w((lambda *s: torch.randn(*s, dtype=torch.bfloat16) * 0.05)(K, C, C) * (1.0 / (K * C) ** 0.5)),
        "mean": _w((lambda *s: torch.randn(*s, dtype=torch.bfloat16) * 0.05)(C) * 0.1),
        "var": _w(torch.abs((lambda *s: torch.randn(*s, dtype=torch.bfloat16) * 0.05)(C)) + 0.5),
        "g": _w((lambda *s: torch.randn(*s, dtype=torch.bfloat16) * 0.05)(C) + 1.0),
        "b": _w((lambda *s: torch.randn(*s, dtype=torch.bfloat16) * 0.05)(C) * 0.1),
    }

def reference(x, w, mean, var, g, b):
    K = 3
    P = K // 2
    S = x.shape[1]
    xp = _pad(x, ((0, 0), (P, P), (0, 0)))
    y = sum(torch.einsum('bsc,cd->bsd', xp[:, k:k + S, :], w[k]) for k in range(K))
    inv_std = 1.0 / torch.sqrt(var + 1e-5)
    y = (y - mean) * (g * inv_std) + b
    return _silu(y)
```

```asm
; @launch grid=(256,1,1) block=(256,1,1) lds=156160
.amdgcn_target "amdgcn-amd-amdhsa--gfx950"
.text
.globl standalone__batchnorm__sampling_kernel
.p2align 12
.p2align 8
.type standalone__batchnorm__sampling_kernel,@function
standalone__batchnorm__sampling_kernel:
    s_load_dwordx16 s[4:19], s[0:1], 0
    s_cmp_ge_u32 s2, 256
    s_cbranch_scc1 L_end
    s_getpc_b64 s[42:43]
L_pc:
    s_lshl_b32 s44, s2, 10
    s_and_b32 s44, s44, 0x6000
    s_add_u32 s44, s44, L_body-L_pc
    v_lshrrev_b32_e32 v145, 6, v0
    v_lshl_add_u32 v145, v145, 11, s44
    v_bfe_u32 v144, v0, 5, 1
    v_add_u32_e32 v144, -1, v144
    v_and_b32_e32 v145, v144, v145
    v_bfe_u32 v144, v0, 1, 4
    v_lshl_add_u32 v144, v144, 7, v145
    v_min_u32_e32 v144, L_end-L_pc, v144
    v_mov_b32_e32 v145, s43
    v_add_co_u32_e32 v144, vcc, s42, v144
    s_nop 1
    v_addc_co_u32_e32 v145, vcc, 0, v145, vcc
    global_load_dword v144, v[144:145], off
    v_lshrrev_b32_e32 v1, 6, v0
    v_and_b32_e32 v0, 63, v0
    v_readfirstlane_b32 s32, v1
    s_and_b32 s42, s2, 7
    s_lshl_b32 s42, s42, 3
    s_lshr_b32 s44, s2, 5
    s_add_u32 s42, s42, s44
    s_lshl_b32 s51, s42, 18
    s_bfe_u32 s43, s2, 0x20003
    s_add_u32 s44, s44, s43
    s_and_b32 s45, s44, 0
    s_and_b32 s46, s2, 7
    s_xor_b32 s45, s45, s46
    s_lshl_b32 s52, s45, 16
    s_lshl_b32 s48, s45, 7
    s_lshl_b32 s43, s43, 8
    s_lshl_b32 s44, s32, 6
    s_add_u32 s50, s43, s44
    s_add_u32 s49, s50, s51
    v_lshrrev_b32_e32 v1, 2, v0
    v_lshlrev_b32_e32 v2, 10, v1
    v_and_b32_e32 v3, 3, v0
    v_lshlrev_b32_e32 v3, 4, v3
    v_add3_u32 v163, v2, v3, s50
    v_add_u32_e32 v164, 15360, v163
    s_mul_i32 s33, s32, 18560
    s_add_u32 s33, s33, 81920
    s_and_b32 s45, s32, 1
    s_lshr_b32 s46, s32, 1
    s_lshl_b32 s46, s46, 10
    s_mul_i32 s47, s45, 40960
    s_add_u32 s34, s47, s46
    s_lshl_b32 s47, s45, 5
    v_xor_b32_e32 v3, s47, v3
    v_and_b32_e32 v1, 7, v1
    v_lshl_add_u32 v3, v1, 14, v3
    v_lshrrev_b32_e32 v1, 5, v0
    v_lshl_add_u32 v3, v1, 6, v3
    s_lshl_b32 s47, s45, 17
    s_add_u32 s46, s46, s47
    s_add_u32 s46, s46, s51
    v_add_u32_e32 v162, s46, v3
    s_mov_b32 s26, 0x180000
    s_mov_b32 s27, 0x20000
    s_mov_b32 s22, 0x1000000
    s_mov_b32 s23, 0x20000
    s_waitcnt lgkmcnt(0)
    s_mov_b32 s24, s6
    s_and_b32 s25, s7, 0xffff
    s_mov_b32 s20, s4
    s_and_b32 s21, s5, 0xffff
    s_add_u32 m0, s34, 0
    s_xor_b32 s37, s48, 0
    buffer_load_dwordx4 v162, s[20:23], s37 offen lds
    buffer_load_dwordx4 v162, s[20:23], s37 offen offset:2048 lds
    s_add_u32 m0, s34, 4096
    s_xor_b32 s37, s48, 4096
    buffer_load_dwordx4 v162, s[20:23], s37 offen lds
    s_xor_b32 s3, s52, 0
    s_add_u32 m0, s33, 12288
    s_add_u32 s36, s3, 524288
    buffer_load_dwordx4 v163, s[24:27], s36 offen lds
    buffer_load_dwordx4 v164, s[24:27], s36 offen offset:1024 lds
    s_add_u32 m0, s33, 14336
    s_add_u32 s36, s3, 1048576
    buffer_load_dwordx4 v163, s[24:27], s36 offen lds
    buffer_load_dwordx4 v164, s[24:27], s36 offen offset:1024 lds
    s_add_u32 m0, s33, 16384
    s_add_u32 s36, s3, 0
    buffer_load_dwordx4 v163, s[24:27], s36 offen lds
    buffer_load_dwordx4 v164, s[24:27], s36 offen offset:1024 lds
    v_lshrrev_b32_e32 v2, 4, v0
    v_bfe_u32 v1, v0, 3, 1
    v_lshlrev_b32_e32 v3, 1, v1
    v_xor_b32_e32 v3, v3, v2
    v_lshlrev_b32_e32 v3, 4, v3
    v_and_b32_e32 v4, 7, v0
    v_lshl_add_u32 v3, v4, 6, v3
    v_mul_u32_u24_e32 v1, 40960, v1
    v_add_u32_e32 v160, v1, v3
    v_and_b32_e32 v3, 15, v0
    v_lshlrev_b32_e32 v3, 4, v3
    v_lshl_add_u32 v3, v2, 9, v3
    v_add_u32_e32 v161, s33, v3
    v_and_b32_e32 v4, 48, v0
    v_add_u32_e32 v156, s50, v4
    v_mov_b32_e32 v165, 0
    v_mov_b32_e32 v166, s49
    v_bfe_u32 v1, v0, 2, 2
    v_mul_u32_u24_e32 v1, 18560, v1
    v_and_b32_e32 v2, 3, v0
    v_mul_u32_u24_e32 v2, 1056, v2
    v_add3_u32 v1, v1, v2, v4
    v_add_u32_e32 v167, 81920, v1
    s_lshr_b32 s42, s32, 1
    s_mul_i32 s42, s42, 40960
    s_and_b32 s43, s32, 1
    s_mul_i32 s43, s43, 4224
    s_add_u32 s35, s42, s43
    s_mov_b32 s38, 0x3fb8aa3b
    s_movk_i32 s39, 4096
    s_movk_i32 s40, 8192
    s_movk_i32 s41, 12288
    s_mov_b32 s28, s16
    s_and_b32 s29, s17, 0xffff
    s_mov_b32 s30, 0x1000000
    s_mov_b32 s31, 0x20000
    s_mov_b32 s54, 1
    s_cmp_eq_u32 s32, 1
    s_cbranch_scc1 L_hop2
    s_cmp_eq_u32 s32, 2
    s_cbranch_scc1 L_hop4
    s_cmp_eq_u32 s32, 3
    s_cbranch_scc1 L_hop6
    s_branch L_hop0
L_back:
    s_mov_b32 s54, 0
    s_add_u32 m0, s34, 6144
    s_xor_b32 s37, s48, 6144
    buffer_load_dwordx4 v162, s[20:23], s37 offen lds
    buffer_load_dwordx4 v162, s[20:23], s37 offen offset:2048 lds
    s_add_u32 m0, s34, 30720
    s_xor_b32 s37, s48, 10240
    buffer_load_dwordx4 v162, s[20:23], s37 offen lds
    buffer_load_dwordx4 v162, s[20:23], s37 offen offset:2048 lds
    s_add_u32 m0, s34, 34816
    s_xor_b32 s37, s48, 14336
    buffer_load_dwordx4 v162, s[20:23], s37 offen lds
    s_waitcnt vmcnt(9)
    ds_read_b64_tr_b16 v[208:209], v161 offset:12288
    ds_read_b64_tr_b16 v[210:211], v161 offset:12544
    ds_read_b64_tr_b16 v[212:213], v161 offset:12296
    ds_read_b64_tr_b16 v[214:215], v161 offset:12552
    s_waitcnt vmcnt(7)
    ds_read_b64_tr_b16 v[216:217], v161 offset:14336
    ds_read_b64_tr_b16 v[218:219], v161 offset:14592
    ds_read_b64_tr_b16 v[220:221], v161 offset:14344
    ds_read_b64_tr_b16 v[222:223], v161 offset:14600
    s_barrier
    ds_read_b128 v[128:131], v160 offset:0
    ds_read_b128 v[132:135], v160 offset:1024
    ds_read_b128 v[136:139], v160 offset:2048
    ds_read_b128 v[140:143], v160 offset:3072
    s_branch L_body
.p2align 12
L_body:
L_hop0:
    s_cmp_eq_u32 s54, 1
    s_cbranch_scc1 L_hop1
    s_waitcnt lgkmcnt(3)
    v_mfma_f32_16x16x32_bf16 v[0:3], v[208:211], v[128:131], 0
    s_waitcnt lgkmcnt(2)
    s_xor_b32 s3, s52, 32768
    s_add_u32 m0, s33, 0
    v_mfma_f32_16x16x32_bf16 v[0:3], v[216:219], v[132:135], v[0:3]
    s_add_u32 s36, s3, 524288
    v_mfma_f32_16x16x32_bf16 v[4:7], v[212:215], v[128:131], 0
    ds_read_b128 v[128:131], v160 offset:4096
    v_mfma_f32_16x16x32_bf16 v[4:7], v[220:223], v[132:135], v[4:7]
    buffer_load_dwordx4 v163, s[24:27], s36 offen lds
    v_mfma_f32_16x16x32_bf16 v[8:11], v[208:211], v[132:135], 0
    s_waitcnt lgkmcnt(2)
    v_mfma_f32_16x16x32_bf16 v[8:11], v[216:219], v[136:139], v[8:11]
    v_mfma_f32_16x16x32_bf16 v[12:15], v[212:215], v[132:135], 0
    ds_read_b128 v[132:135], v160 offset:5120
    v_mfma_f32_16x16x32_bf16 v[12:15], v[220:223], v[136:139], v[12:15]
    v_mfma_f32_16x16x32_bf16 v[16:19], v[208:211], v[136:139], 0
    s_waitcnt lgkmcnt(2)
    v_mfma_f32_16x16x32_bf16 v[16:19], v[216:219], v[140:143], v[16:19]
    buffer_load_dwordx4 v164, s[24:27], s36 offen offset:1024 lds
    v_mfma_f32_16x16x32_bf16 v[20:23], v[212:215], v[136:139], 0
    ds_read_b128 v[136:139], v160 offset:0
    v_mfma_f32_16x16x32_bf16 v[20:23], v[220:223], v[140:143], v[20:23]
    v_mfma_f32_16x16x32_bf16 v[24:27], v[208:211], v[140:143], 0
    s_waitcnt lgkmcnt(2)
    s_waitcnt vmcnt(7)
    ds_read_b64_tr_b16 v[200:201], v161 offset:16384
    v_mfma_f32_16x16x32_bf16 v[24:27], v[216:219], v[128:131], v[24:27]
    s_add_u32 m0, s33, 2048
    s_add_u32 s36, s3, 1048576
    ds_read_b64_tr_b16 v[202:203], v161 offset:16640
    v_mfma_f32_16x16x32_bf16 v[28:31], v[212:215], v[140:143], 0
    ds_read_b128 v[140:143], v160 offset:1024
    v_mfma_f32_16x16x32_bf16 v[28:31], v[220:223], v[128:131], v[28:31]
    ds_read_b64_tr_b16 v[204:205], v161 offset:16392
    v_mfma_f32_16x16x32_bf16 v[32:35], v[208:211], v[128:131], 0
    s_waitcnt lgkmcnt(5)
    ds_read_b64_tr_b16 v[206:207], v161 offset:16648
    v_mfma_f32_16x16x32_bf16 v[32:35], v[216:219], v[132:135], v[32:35]
    buffer_load_dwordx4 v163, s[24:27], s36 offen lds
    v_mfma_f32_16x16x32_bf16 v[36:39], v[212:215], v[128:131], 0
    ds_read_b128 v[128:131], v160 offset:2048
    v_mfma_f32_16x16x32_bf16 v[36:39], v[220:223], v[132:135], v[36:39]
    v_mfma_f32_16x16x32_bf16 v[40:43], v[208:211], v[132:135], 0
    v_mfma_f32_16x16x32_bf16 v[44:47], v[212:215], v[132:135], 0
    s_waitcnt lgkmcnt(1)
    ds_read_b128 v[132:135], v160 offset:3072
    v_mfma_f32_16x16x32_bf16 v[8:11], v[200:203], v[136:139], v[8:11]
    v_mfma_f32_16x16x32_bf16 v[12:15], v[204:207], v[136:139], v[12:15]
    buffer_load_dwordx4 v164, s[24:27], s36 offen offset:1024 lds
    v_mfma_f32_16x16x32_bf16 v[16:19], v[200:203], v[140:143], v[16:19]
    s_waitcnt vmcnt(7)
    s_barrier
    ds_read_b128 v[136:139], v160 offset:4096
    v_mfma_f32_16x16x32_bf16 v[20:23], v[204:207], v[140:143], v[20:23]
    s_waitcnt lgkmcnt(2)
    ds_read_b128 v[140:143], v160 offset:5120
    v_mfma_f32_16x16x32_bf16 v[24:27], v[200:203], v[128:131], v[24:27]
    s_add_u32 m0, s33, 4096
    s_add_u32 s36, s3, 0
    v_mfma_f32_16x16x32_bf16 v[28:31], v[204:207], v[128:131], v[28:31]
    s_waitcnt lgkmcnt(2)
    ds_read_b128 v[128:131], v160 offset:6144
    v_mfma_f32_16x16x32_bf16 v[32:35], v[200:203], v[132:135], v[32:35]
    v_mfma_f32_16x16x32_bf16 v[36:39], v[204:207], v[132:135], v[36:39]
    s_waitcnt lgkmcnt(2)
    buffer_load_dwordx4 v163, s[24:27], s36 offen lds
    v_mfma_f32_16x16x32_bf16 v[40:43], v[200:203], v[136:139], v[40:43]
    ds_read_b128 v[132:135], v160 offset:7168
    v_mfma_f32_16x16x32_bf16 v[44:47], v[204:207], v[136:139], v[44:47]
    s_waitcnt lgkmcnt(2)
    ds_read_b128 v[136:139], v160 offset:8192
    v_mfma_f32_16x16x32_bf16 v[48:51], v[200:203], v[140:143], 0
    v_mfma_f32_16x16x32_bf16 v[52:55], v[204:207], v[140:143], 0
    s_waitcnt lgkmcnt(2)
    v_mfma_f32_16x16x32_bf16 v[40:43], v[216:219], v[128:131], v[40:43]
    v_mfma_f32_16x16x32_bf16 v[44:47], v[220:223], v[128:131], v[44:47]
    buffer_load_dwordx4 v164, s[24:27], s36 offen offset:1024 lds
    v_mfma_f32_16x16x32_bf16 v[48:51], v[208:211], v[128:131], v[48:51]
    s_waitcnt lgkmcnt(1)
    ds_read_b128 v[140:143], v160 offset:9216
    v_mfma_f32_16x16x32_bf16 v[48:51], v[216:219], v[132:135], v[48:51]
    v_mfma_f32_16x16x32_bf16 v[52:55], v[212:215], v[128:131], v[52:55]
    s_xor_b32 s3, s52, 65536
    s_add_u32 m0, s33, 6144
    s_add_u32 s36, s3, 524288
    v_mfma_f32_16x16x32_bf16 v[52:55], v[220:223], v[132:135], v[52:55]
    v_mfma_f32_16x16x32_bf16 v[56:59], v[200:203], v[128:131], 0
    v_mfma_f32_16x16x32_bf16 v[56:59], v[208:211], v[132:135], v[56:59]
    s_waitcnt lgkmcnt(1)
    buffer_load_dwordx4 v163, s[24:27], s36 offen lds
    v_mfma_f32_16x16x32_bf16 v[56:59], v[216:219], v[136:139], v[56:59]
    v_mfma_f32_16x16x32_bf16 v[60:63], v[204:207], v[128:131], 0
    v_mfma_f32_16x16x32_bf16 v[60:63], v[212:215], v[132:135], v[60:63]
    s_waitcnt vmcnt(7)
    s_barrier
    v_mfma_f32_16x16x32_bf16 v[60:63], v[220:223], v[136:139], v[60:63]
    ds_read_b128 v[128:131], v160 offset:30720
    v_mfma_f32_16x16x32_bf16 v[64:67], v[200:203], v[132:135], 0
    v_mfma_f32_16x16x32_bf16 v[64:67], v[208:211], v[136:139], v[64:67]
    s_waitcnt lgkmcnt(1)
    buffer_load_dwordx4 v164, s[24:27], s36 offen offset:1024 lds
    v_mfma_f32_16x16x32_bf16 v[64:67], v[216:219], v[140:143], v[64:67]
    v_mfma_f32_16x16x32_bf16 v[68:71], v[204:207], v[132:135], 0
    ds_read_b128 v[132:135], v160 offset:31744
    v_mfma_f32_16x16x32_bf16 v[68:71], v[212:215], v[136:139], v[68:71]
    s_add_u32 m0, s33, 8192
    s_add_u32 s36, s3, 1048576
    v_mfma_f32_16x16x32_bf16 v[68:71], v[220:223], v[140:143], v[68:71]
    v_mfma_f32_16x16x32_bf16 v[72:75], v[200:203], v[136:139], 0
    v_mfma_f32_16x16x32_bf16 v[72:75], v[208:211], v[140:143], v[72:75]
    s_waitcnt lgkmcnt(1)
    buffer_load_dwordx4 v163, s[24:27], s36 offen lds
    v_mfma_f32_16x16x32_bf16 v[72:75], v[216:219], v[128:131], v[72:75]
    v_mfma_f32_16x16x32_bf16 v[76:79], v[204:207], v[136:139], 0
    ds_read_b128 v[136:139], v160 offset:32768
    v_mfma_f32_16x16x32_bf16 v[76:79], v[212:215], v[140:143], v[76:79]
    v_mfma_f32_16x16x32_bf16 v[76:79], v[220:223], v[128:131], v[76:79]
    v_mfma_f32_16x16x32_bf16 v[80:83], v[200:203], v[140:143], 0
    v_mfma_f32_16x16x32_bf16 v[80:83], v[208:211], v[128:131], v[80:83]
    s_waitcnt lgkmcnt(1)
    buffer_load_dwordx4 v164, s[24:27], s36 offen offset:1024 lds
    v_mfma_f32_16x16x32_bf16 v[80:83], v[216:219], v[132:135], v[80:83]
    v_mfma_f32_16x16x32_bf16 v[84:87], v[204:207], v[140:143], 0
    ds_read_b128 v[140:143], v160 offset:33792
    v_mfma_f32_16x16x32_bf16 v[84:87], v[212:215], v[128:131], v[84:87]
    s_add_u32 m0, s33, 10240
    s_add_u32 s36, s3, 0
    v_mfma_f32_16x16x32_bf16 v[84:87], v[220:223], v[132:135], v[84:87]
    v_mfma_f32_16x16x32_bf16 v[88:91], v[200:203], v[128:131], 0
    v_mfma_f32_16x16x32_bf16 v[88:91], v[208:211], v[132:135], v[88:91]
    s_waitcnt lgkmcnt(1)
    buffer_load_dwordx4 v163, s[24:27], s36 offen lds
    v_mfma_f32_16x16x32_bf16 v[88:91], v[216:219], v[136:139], v[88:91]
    s_waitcnt vmcnt(9)
    ds_read_b64_tr_b16 v[232:233], v161 offset:0
    v_mfma_f32_16x16x32_bf16 v[92:95], v[204:207], v[128:131], 0
    ds_read_b128 v[128:131], v160 offset:34816
    v_mfma_f32_16x16x32_bf16 v[92:95], v[212:215], v[132:135], v[92:95]
    ds_read_b64_tr_b16 v[234:235], v161 offset:256
    v_mfma_f32_16x16x32_bf16 v[92:95], v[220:223], v[136:139], v[92:95]
    ds_read_b64_tr_b16 v[236:237], v161 offset:8
    v_mfma_f32_16x16x32_bf16 v[96:99], v[200:203], v[132:135], 0
    ds_read_b64_tr_b16 v[238:239], v161 offset:264
    v_mfma_f32_16x16x32_bf16 v[96:99], v[208:211], v[136:139], v[96:99]
    s_waitcnt lgkmcnt(5)
    buffer_load_dwordx4 v164, s[24:27], s36 offen offset:1024 lds
    v_mfma_f32_16x16x32_bf16 v[96:99], v[216:219], v[140:143], v[96:99]
    s_waitcnt vmcnt(8)
    ds_read_b64_tr_b16 v[240:241], v161 offset:2048
    v_mfma_f32_16x16x32_bf16 v[100:103], v[204:207], v[132:135], 0
    ds_read_b128 v[132:135], v160 offset:35840
    v_mfma_f32_16x16x32_bf16 v[100:103], v[212:215], v[136:139], v[100:103]
    s_add_u32 m0, s34, 10240
    s_xor_b32 s37, s48, 128
    ds_read_b64_tr_b16 v[242:243], v161 offset:2304
    v_mfma_f32_16x16x32_bf16 v[100:103], v[220:223], v[140:143], v[100:103]
    ds_read_b64_tr_b16 v[244:245], v161 offset:2056
    v_mfma_f32_16x16x32_bf16 v[104:107], v[200:203], v[136:139], 0
    ds_read_b64_tr_b16 v[246:247], v161 offset:2312
    v_mfma_f32_16x16x32_bf16 v[104:107], v[208:211], v[140:143], v[104:107]
    s_waitcnt lgkmcnt(8)
    buffer_load_dwordx4 v162, s[20:23], s37 offen lds
    v_mfma_f32_16x16x32_bf16 v[104:107], v[216:219], v[128:131], v[104:107]
    s_waitcnt vmcnt(7)
    ds_read_b64_tr_b16 v[224:225], v161 offset:4096
    v_mfma_f32_16x16x32_bf16 v[108:111], v[204:207], v[136:139], 0
    ds_read_b64_tr_b16 v[226:227], v161 offset:4352
    v_mfma_f32_16x16x32_bf16 v[108:111], v[212:215], v[140:143], v[108:111]
    ds_read_b128 v[136:139], v160 offset:512
    v_mfma_f32_16x16x32_bf16 v[108:111], v[220:223], v[128:131], v[108:111]
    ds_read_b64_tr_b16 v[228:229], v161 offset:4104
    v_mfma_f32_16x16x32_bf16 v[112:115], v[200:203], v[140:143], 0
    ds_read_b64_tr_b16 v[230:231], v161 offset:4360
    v_mfma_f32_16x16x32_bf16 v[112:115], v[208:211], v[128:131], v[112:115]
    s_waitcnt lgkmcnt(8)
    buffer_load_dwordx4 v162, s[20:23], s37 offen offset:2048 lds
    v_mfma_f32_16x16x32_bf16 v[112:115], v[216:219], v[132:135], v[112:115]
    v_mfma_f32_16x16x32_bf16 v[116:119], v[204:207], v[140:143], 0
    ds_read_b128 v[140:143], v160 offset:1536
    v_mfma_f32_16x16x32_bf16 v[116:119], v[212:215], v[128:131], v[116:119]
    s_add_u32 m0, s34, 14336
    s_xor_b32 s37, s48, 4224
    v_mfma_f32_16x16x32_bf16 v[116:119], v[220:223], v[132:135], v[116:119]
    v_mfma_f32_16x16x32_bf16 v[120:123], v[200:203], v[128:131], 0
    v_mfma_f32_16x16x32_bf16 v[120:123], v[208:211], v[132:135], v[120:123]
    buffer_load_dwordx4 v162, s[20:23], s37 offen lds
    v_mfma_f32_16x16x32_bf16 v[124:127], v[204:207], v[128:131], 0
    ds_read_b128 v[128:131], v160 offset:2560
    v_mfma_f32_16x16x32_bf16 v[124:127], v[212:215], v[132:135], v[124:127]
    s_waitcnt lgkmcnt(2)
    v_mfma_f32_16x16x32_bf16 v[0:3], v[232:235], v[136:139], v[0:3]
    s_waitcnt lgkmcnt(1)
    ds_read_b128 v[132:135], v160 offset:3584
    v_mfma_f32_16x16x32_bf16 v[0:3], v[240:243], v[140:143], v[0:3]
    v_mfma_f32_16x16x32_bf16 v[4:7], v[236:239], v[136:139], v[4:7]
    v_mfma_f32_16x16x32_bf16 v[4:7], v[244:247], v[140:143], v[4:7]
    buffer_load_dwordx4 v162, s[20:23], s37 offen offset:2048 lds
    v_mfma_f32_16x16x32_bf16 v[8:11], v[224:227], v[136:139], v[8:11]
    v_mfma_f32_16x16x32_bf16 v[8:11], v[232:235], v[140:143], v[8:11]
    s_waitcnt lgkmcnt(1)
    v_mfma_f32_16x16x32_bf16 v[8:11], v[240:243], v[128:131], v[8:11]
    s_add_u32 m0, s34, 18432
    s_xor_b32 s37, s48, 8320
    v_mfma_f32_16x16x32_bf16 v[12:15], v[228:231], v[136:139], v[12:15]
    ds_read_b128 v[136:139], v160 offset:4608
    v_mfma_f32_16x16x32_bf16 v[12:15], v[236:239], v[140:143], v[12:15]
    v_mfma_f32_16x16x32_bf16 v[12:15], v[244:247], v[128:131], v[12:15]
    buffer_load_dwordx4 v162, s[20:23], s37 offen lds
    v_mfma_f32_16x16x32_bf16 v[16:19], v[224:227], v[140:143], v[16:19]
    v_mfma_f32_16x16x32_bf16 v[16:19], v[232:235], v[128:131], v[16:19]
    s_waitcnt lgkmcnt(1)
    v_mfma_f32_16x16x32_bf16 v[16:19], v[240:243], v[132:135], v[16:19]
    s_xor_b32 s3, s52, 98304
    s_add_u32 m0, s33, 12288
    s_add_u32 s36, s3, 524288
    v_mfma_f32_16x16x32_bf16 v[20:23], v[228:231], v[140:143], v[20:23]
    ds_read_b128 v[140:143], v160 offset:5632
    v_mfma_f32_16x16x32_bf16 v[20:23], v[236:239], v[128:131], v[20:23]
    v_mfma_f32_16x16x32_bf16 v[20:23], v[244:247], v[132:135], v[20:23]
    buffer_load_dwordx4 v163, s[24:27], s36 offen lds
    v_mfma_f32_16x16x32_bf16 v[24:27], v[224:227], v[128:131], v[24:27]
    v_mfma_f32_16x16x32_bf16 v[24:27], v[232:235], v[132:135], v[24:27]
    s_waitcnt lgkmcnt(1)
    v_mfma_f32_16x16x32_bf16 v[24:27], v[240:243], v[136:139], v[24:27]
    v_mfma_f32_16x16x32_bf16 v[28:31], v[228:231], v[128:131], v[28:31]
    ds_read_b128 v[128:131], v160 offset:6656
    v_mfma_f32_16x16x32_bf16 v[28:31], v[236:239], v[132:135], v[28:31]
    v_mfma_f32_16x16x32_bf16 v[28:31], v[244:247], v[136:139], v[28:31]
    buffer_load_dwordx4 v164, s[24:27], s36 offen offset:1024 lds
    v_mfma_f32_16x16x32_bf16 v[32:35], v[224:227], v[132:135], v[32:35]
    v_mfma_f32_16x16x32_bf16 v[32:35], v[232:235], v[136:139], v[32:35]
    s_waitcnt lgkmcnt(1)
    v_mfma_f32_16x16x32_bf16 v[32:35], v[240:243], v[140:143], v[32:35]
    s_add_u32 m0, s33, 14336
    s_add_u32 s36, s3, 1048576
    v_mfma_f32_16x16x32_bf16 v[36:39], v[228:231], v[132:135], v[36:39]
    ds_read_b128 v[132:135], v160 offset:7680
    v_mfma_f32_16x16x32_bf16 v[36:39], v[236:239], v[136:139], v[36:39]
    v_mfma_f32_16x16x32_bf16 v[36:39], v[244:247], v[140:143], v[36:39]
    buffer_load_dwordx4 v163, s[24:27], s36 offen lds
    v_mfma_f32_16x16x32_bf16 v[40:43], v[224:227], v[136:139], v[40:43]
    v_mfma_f32_16x16x32_bf16 v[40:43], v[232:235], v[140:143], v[40:43]
    s_waitcnt lgkmcnt(1)
    v_mfma_f32_16x16x32_bf16 v[40:43], v[240:243], v[128:131], v[40:43]
    v_mfma_f32_16x16x32_bf16 v[44:47], v[228:231], v[136:139], v[44:47]
    ds_read_b128 v[136:139], v160 offset:8704
    v_mfma_f32_16x16x32_bf16 v[44:47], v[236:239], v[140:143], v[44:47]
    v_mfma_f32_16x16x32_bf16 v[44:47], v[244:247], v[128:131], v[44:47]
    buffer_load_dwordx4 v164, s[24:27], s36 offen offset:1024 lds
    v_mfma_f32_16x16x32_bf16 v[48:51], v[224:227], v[140:143], v[48:51]
    v_mfma_f32_16x16x32_bf16 v[48:51], v[232:235], v[128:131], v[48:51]
    s_waitcnt lgkmcnt(1)
    v_mfma_f32_16x16x32_bf16 v[48:51], v[240:243], v[132:135], v[48:51]
    s_add_u32 m0, s33, 16384
    s_add_u32 s36, s3, 0
    v_mfma_f32_16x16x32_bf16 v[52:55], v[228:231], v[140:143], v[52:55]
    ds_read_b128 v[140:143], v160 offset:9728
    v_mfma_f32_16x16x32_bf16 v[52:55], v[236:239], v[128:131], v[52:55]
    v_mfma_f32_16x16x32_bf16 v[52:55], v[244:247], v[132:135], v[52:55]
    buffer_load_dwordx4 v163, s[24:27], s36 offen lds
    v_mfma_f32_16x16x32_bf16 v[56:59], v[224:227], v[128:131], v[56:59]
    v_mfma_f32_16x16x32_bf16 v[56:59], v[232:235], v[132:135], v[56:59]
    s_waitcnt lgkmcnt(1)
    v_mfma_f32_16x16x32_bf16 v[56:59], v[240:243], v[136:139], v[56:59]
    v_mfma_f32_16x16x32_bf16 v[60:63], v[228:231], v[128:131], v[60:63]
    ds_read_b128 v[128:131], v160 offset:31232
    v_mfma_f32_16x16x32_bf16 v[60:63], v[236:239], v[132:135], v[60:63]
    v_mfma_f32_16x16x32_bf16 v[60:63], v[244:247], v[136:139], v[60:63]
    buffer_load_dwordx4 v164, s[24:27], s36 offen offset:1024 lds
    v_mfma_f32_16x16x32_bf16 v[64:67], v[224:227], v[132:135], v[64:67]
    v_mfma_f32_16x16x32_bf16 v[64:67], v[232:235], v[136:139], v[64:67]
    s_waitcnt lgkmcnt(1)
    v_mfma_f32_16x16x32_bf16 v[64:67], v[240:243], v[140:143], v[64:67]
    s_xor_b32 s3, s52, 131072
    s_add_u32 m0, s33, 0
    s_add_u32 s36, s3, 524288
    v_mfma_f32_16x16x32_bf16 v[68:71], v[228:231], v[132:135], v[68:71]
    ds_read_b128 v[132:135], v160 offset:32256
    v_mfma_f32_16x16x32_bf16 v[68:71], v[236:239], v[136:139], v[68:71]
    v_mfma_f32_16x16x32_bf16 v[68:71], v[244:247], v[140:143], v[68:71]
    buffer_load_dwordx4 v163, s[24:27], s36 offen lds
    v_mfma_f32_16x16x32_bf16 v[72:75], v[224:227], v[136:139], v[72:75]
    v_mfma_f32_16x16x32_bf16 v[72:75], v[232:235], v[140:143], v[72:75]
    s_waitcnt lgkmcnt(1)
    v_mfma_f32_16x16x32_bf16 v[72:75], v[240:243], v[128:131], v[72:75]
    v_mfma_f32_16x16x32_bf16 v[76:79], v[228:231], v[136:139], v[76:79]
    ds_read_b128 v[136:139], v160 offset:33280
    v_mfma_f32_16x16x32_bf16 v[76:79], v[236:239], v[140:143], v[76:79]
    v_mfma_f32_16x16x32_bf16 v[76:79], v[244:247], v[128:131], v[76:79]
    buffer_load_dwordx4 v164, s[24:27], s36 offen offset:1024 lds
    v_mfma_f32_16x16x32_bf16 v[80:83], v[224:227], v[140:143], v[80:83]
    v_mfma_f32_16x16x32_bf16 v[80:83], v[232:235], v[128:131], v[80:83]
    s_waitcnt lgkmcnt(1)
    v_mfma_f32_16x16x32_bf16 v[80:83], v[240:243], v[132:135], v[80:83]
    s_add_u32 m0, s33, 2048
    s_add_u32 s36, s3, 1048576
    v_mfma_f32_16x16x32_bf16 v[84:87], v[228:231], v[140:143], v[84:87]
    ds_read_b128 v[140:143], v160 offset:34304
    v_mfma_f32_16x16x32_bf16 v[84:87], v[236:239], v[128:131], v[84:87]
    v_mfma_f32_16x16x32_bf16 v[84:87], v[244:247], v[132:135], v[84:87]
    buffer_load_dwordx4 v163, s[24:27], s36 offen lds
    v_mfma_f32_16x16x32_bf16 v[88:91], v[224:227], v[128:131], v[88:91]
    v_mfma_f32_16x16x32_bf16 v[88:91], v[232:235], v[132:135], v[88:91]
    s_waitcnt lgkmcnt(1)
    v_mfma_f32_16x16x32_bf16 v[88:91], v[240:243], v[136:139], v[88:91]
    s_waitcnt vmcnt(18)
    ds_read_b64_tr_b16 a[8:9], v161 offset:6144
    v_mfma_f32_16x16x32_bf16 v[92:95], v[228:231], v[128:131], v[92:95]
    ds_read_b128 v[128:131], v160 offset:35328
    v_mfma_f32_16x16x32_bf16 v[92:95], v[236:239], v[132:135], v[92:95]
    ds_read_b64_tr_b16 a[10:11], v161 offset:6400
    v_mfma_f32_16x16x32_bf16 v[92:95], v[244:247], v[136:139], v[92:95]
    buffer_load_dwordx4 v164, s[24:27], s36 offen offset:1024 lds
    v_mfma_f32_16x16x32_bf16 v[96:99], v[224:227], v[132:135], v[96:99]
    ds_read_b64_tr_b16 a[12:13], v161 offset:6152
    v_mfma_f32_16x16x32_bf16 v[96:99], v[232:235], v[136:139], v[96:99]
    s_waitcnt lgkmcnt(4)
    ds_read_b64_tr_b16 a[14:15], v161 offset:6408
    v_mfma_f32_16x16x32_bf16 v[96:99], v[240:243], v[140:143], v[96:99]
    s_waitcnt vmcnt(17)
    s_add_u32 m0, s33, 4096
    ds_read_b64_tr_b16 a[16:17], v161 offset:8192
    v_mfma_f32_16x16x32_bf16 v[100:103], v[228:231], v[132:135], v[100:103]
    s_add_u32 s36, s3, 0
    ds_read_b128 v[132:135], v160 offset:36352
    v_mfma_f32_16x16x32_bf16 v[100:103], v[236:239], v[136:139], v[100:103]
    ds_read_b64_tr_b16 a[18:19], v161 offset:8448
    v_mfma_f32_16x16x32_bf16 v[100:103], v[244:247], v[140:143], v[100:103]
    buffer_load_dwordx4 v163, s[24:27], s36 offen lds
    v_mfma_f32_16x16x32_bf16 v[104:107], v[224:227], v[136:139], v[104:107]
    ds_read_b64_tr_b16 a[20:21], v161 offset:8200
    v_mfma_f32_16x16x32_bf16 v[104:107], v[232:235], v[140:143], v[104:107]
    s_waitcnt lgkmcnt(7)
    ds_read_b64_tr_b16 a[22:23], v161 offset:8456
    v_mfma_f32_16x16x32_bf16 v[104:107], v[240:243], v[128:131], v[104:107]
    s_waitcnt vmcnt(16)
    ds_read_b64_tr_b16 a[0:1], v161 offset:10240
    v_mfma_f32_16x16x32_bf16 v[108:111], v[228:231], v[136:139], v[108:111]
    ds_read_b64_tr_b16 a[2:3], v161 offset:10496
    v_mfma_f32_16x16x32_bf16 v[108:111], v[236:239], v[140:143], v[108:111]
    ds_read_b64_tr_b16 a[4:5], v161 offset:10248
    v_mfma_f32_16x16x32_bf16 v[108:111], v[244:247], v[128:131], v[108:111]
    buffer_load_dwordx4 v164, s[24:27], s36 offen offset:1024 lds
    v_mfma_f32_16x16x32_bf16 v[112:115], v[224:227], v[140:143], v[112:115]
    s_waitcnt vmcnt(12)
    s_barrier
    ds_read_b64_tr_b16 a[6:7], v161 offset:10504
    v_mfma_f32_16x16x32_bf16 v[112:115], v[232:235], v[128:131], v[112:115]
    s_waitcnt lgkmcnt(7)
    ds_read_b128 v[136:139], v160 offset:10240
    v_mfma_f32_16x16x32_bf16 v[112:115], v[240:243], v[132:135], v[112:115]
    s_add_u32 m0, s34, 20480
    s_xor_b32 s37, s48, 256
    v_mfma_f32_16x16x32_bf16 v[116:119], v[228:231], v[140:143], v[116:119]
    ds_read_b128 v[140:143], v160 offset:11264
    v_mfma_f32_16x16x32_bf16 v[116:119], v[236:239], v[128:131], v[116:119]
    v_mfma_f32_16x16x32_bf16 v[116:119], v[244:247], v[132:135], v[116:119]
    buffer_load_dwordx4 v162, s[20:23], s37 offen lds
    v_mfma_f32_16x16x32_bf16 v[120:123], v[224:227], v[128:131], v[120:123]
    v_mfma_f32_16x16x32_bf16 v[120:123], v[232:235], v[132:135], v[120:123]
    v_mfma_f32_16x16x32_bf16 v[124:127], v[228:231], v[128:131], v[124:127]
    ds_read_b128 v[128:131], v160 offset:12288
    v_mfma_f32_16x16x32_bf16 v[124:127], v[236:239], v[132:135], v[124:127]
    s_waitcnt lgkmcnt(3)
    s_waitcnt lgkmcnt(2)
    v_mfma_f32_16x16x32_bf16 v[0:3], a[8:11], v[136:139], v[0:3]
    s_waitcnt lgkmcnt(1)
    ds_read_b128 v[132:135], v160 offset:13312
    v_mfma_f32_16x16x32_bf16 v[0:3], a[16:19], v[140:143], v[0:3]
    buffer_load_dwordx4 v162, s[20:23], s37 offen offset:2048 lds
    v_mfma_f32_16x16x32_bf16 v[4:7], a[12:15], v[136:139], v[4:7]
    v_mfma_f32_16x16x32_bf16 v[4:7], a[20:23], v[140:143], v[4:7]
    v_mfma_f32_16x16x32_bf16 v[8:11], a[0:3], v[136:139], v[8:11]
    s_add_u32 m0, s34, 24576
    s_xor_b32 s37, s48, 4352
    v_mfma_f32_16x16x32_bf16 v[8:11], a[8:11], v[140:143], v[8:11]
    s_waitcnt lgkmcnt(1)
    v_mfma_f32_16x16x32_bf16 v[8:11], a[16:19], v[128:131], v[8:11]
    v_mfma_f32_16x16x32_bf16 v[12:15], a[4:7], v[136:139], v[12:15]
    buffer_load_dwordx4 v162, s[20:23], s37 offen lds
    v_mfma_f32_16x16x32_bf16 v[12:15], a[12:15], v[140:143], v[12:15]
    ds_read_b128 v[136:139], v160 offset:14336
    v_mfma_f32_16x16x32_bf16 v[12:15], a[20:23], v[128:131], v[12:15]
    v_mfma_f32_16x16x32_bf16 v[16:19], a[0:3], v[140:143], v[16:19]
    v_mfma_f32_16x16x32_bf16 v[16:19], a[8:11], v[128:131], v[16:19]
    s_waitcnt lgkmcnt(1)
    v_mfma_f32_16x16x32_bf16 v[16:19], a[16:19], v[132:135], v[16:19]
    v_mfma_f32_16x16x32_bf16 v[20:23], a[4:7], v[140:143], v[20:23]
    buffer_load_dwordx4 v162, s[20:23], s37 offen offset:2048 lds
    v_mfma_f32_16x16x32_bf16 v[20:23], a[12:15], v[128:131], v[20:23]
    ds_read_b128 v[140:143], v160 offset:15360
    v_mfma_f32_16x16x32_bf16 v[20:23], a[20:23], v[132:135], v[20:23]
    v_mfma_f32_16x16x32_bf16 v[24:27], a[0:3], v[128:131], v[24:27]
    s_add_u32 m0, s34, 28672
    s_xor_b32 s37, s48, 8448
    v_mfma_f32_16x16x32_bf16 v[24:27], a[8:11], v[132:135], v[24:27]
    s_waitcnt lgkmcnt(1)
    v_mfma_f32_16x16x32_bf16 v[24:27], a[16:19], v[136:139], v[24:27]
    v_mfma_f32_16x16x32_bf16 v[28:31], a[4:7], v[128:131], v[28:31]
    buffer_load_dwordx4 v162, s[20:23], s37 offen lds
    v_mfma_f32_16x16x32_bf16 v[28:31], a[12:15], v[132:135], v[28:31]
    ds_read_b128 v[128:131], v160 offset:16384
    v_mfma_f32_16x16x32_bf16 v[28:31], a[20:23], v[136:139], v[28:31]
    v_mfma_f32_16x16x32_bf16 v[32:35], a[0:3], v[132:135], v[32:35]
    s_xor_b32 s3, s52, 163840
    s_add_u32 m0, s33, 6144
    s_add_u32 s36, s3, 524288
    v_mfma_f32_16x16x32_bf16 v[32:35], a[8:11], v[136:139], v[32:35]
    s_waitcnt lgkmcnt(1)
    v_mfma_f32_16x16x32_bf16 v[32:35], a[16:19], v[140:143], v[32:35]
    v_mfma_f32_16x16x32_bf16 v[36:39], a[4:7], v[132:135], v[36:39]
    buffer_load_dwordx4 v163, s[24:27], s36 offen lds
    v_mfma_f32_16x16x32_bf16 v[36:39], a[12:15], v[136:139], v[36:39]
    ds_read_b128 v[132:135], v160 offset:17408
    v_mfma_f32_16x16x32_bf16 v[36:39], a[20:23], v[140:143], v[36:39]
    v_mfma_f32_16x16x32_bf16 v[40:43], a[0:3], v[136:139], v[40:43]
    v_mfma_f32_16x16x32_bf16 v[40:43], a[8:11], v[140:143], v[40:43]
    s_waitcnt lgkmcnt(1)
    v_mfma_f32_16x16x32_bf16 v[40:43], a[16:19], v[128:131], v[40:43]
    v_mfma_f32_16x16x32_bf16 v[44:47], a[4:7], v[136:139], v[44:47]
    buffer_load_dwordx4 v164, s[24:27], s36 offen offset:1024 lds
    v_mfma_f32_16x16x32_bf16 v[44:47], a[12:15], v[140:143], v[44:47]
    s_waitcnt vmcnt(17)
    ds_read_b128 v[136:139], v160 offset:18432
    v_mfma_f32_16x16x32_bf16 v[44:47], a[20:23], v[128:131], v[44:47]
    ds_read_b64_tr_b16 a[32:33], v161 offset:12288
    v_mfma_f32_16x16x32_bf16 v[48:51], a[0:3], v[140:143], v[48:51]
    s_add_u32 m0, s33, 8192
    s_add_u32 s36, s3, 1048576
    ds_read_b64_tr_b16 a[34:35], v161 offset:12544
    v_mfma_f32_16x16x32_bf16 v[48:51], a[8:11], v[128:131], v[48:51]
    s_waitcnt lgkmcnt(3)
    ds_read_b64_tr_b16 a[36:37], v161 offset:12296
    v_mfma_f32_16x16x32_bf16 v[48:51], a[16:19], v[132:135], v[48:51]
    ds_read_b64_tr_b16 a[38:39], v161 offset:12552
    v_mfma_f32_16x16x32_bf16 v[52:55], a[4:7], v[140:143], v[52:55]
    buffer_load_dwordx4 v163, s[24:27], s36 offen lds
    v_mfma_f32_16x16x32_bf16 v[52:55], a[12:15], v[128:131], v[52:55]
    s_waitcnt vmcnt(16)
    ds_read_b128 v[140:143], v160 offset:19456
    v_mfma_f32_16x16x32_bf16 v[52:55], a[20:23], v[132:135], v[52:55]
    ds_read_b64_tr_b16 a[40:41], v161 offset:14336
    v_mfma_f32_16x16x32_bf16 v[56:59], a[0:3], v[128:131], v[56:59]
    ds_read_b64_tr_b16 a[42:43], v161 offset:14592
    v_mfma_f32_16x16x32_bf16 v[56:59], a[8:11], v[132:135], v[56:59]
    s_waitcnt lgkmcnt(7)
    ds_read_b64_tr_b16 a[44:45], v161 offset:14344
    v_mfma_f32_16x16x32_bf16 v[56:59], a[16:19], v[136:139], v[56:59]
    ds_read_b64_tr_b16 a[46:47], v161 offset:14600
    v_mfma_f32_16x16x32_bf16 v[60:63], a[4:7], v[128:131], v[60:63]
    buffer_load_dwordx4 v164, s[24:27], s36 offen offset:1024 lds
    v_mfma_f32_16x16x32_bf16 v[60:63], a[12:15], v[132:135], v[60:63]
    s_waitcnt vmcnt(15)
    ds_read_b64_tr_b16 a[24:25], v161 offset:16384
    v_mfma_f32_16x16x32_bf16 v[60:63], a[20:23], v[136:139], v[60:63]
    ds_read_b64_tr_b16 a[26:27], v161 offset:16640
    v_mfma_f32_16x16x32_bf16 v[64:67], a[0:3], v[132:135], v[64:67]
    s_add_u32 m0, s33, 10240
    s_add_u32 s36, s3, 0
    ds_read_b128 v[128:131], v160 offset:10752
    v_mfma_f32_16x16x32_bf16 v[64:67], a[8:11], v[136:139], v[64:67]
    s_waitcnt lgkmcnt(7)
    ds_read_b64_tr_b16 a[28:29], v161 offset:16392
    v_mfma_f32_16x16x32_bf16 v[64:67], a[16:19], v[140:143], v[64:67]
    ds_read_b64_tr_b16 a[30:31], v161 offset:16648
    v_mfma_f32_16x16x32_bf16 v[68:71], a[4:7], v[132:135], v[68:71]
    buffer_load_dwordx4 v163, s[24:27], s36 offen lds
    v_mfma_f32_16x16x32_bf16 v[68:71], a[12:15], v[136:139], v[68:71]
    ds_read_b128 v[132:135], v160 offset:11776
    v_mfma_f32_16x16x32_bf16 v[68:71], a[20:23], v[140:143], v[68:71]
    v_mfma_f32_16x16x32_bf16 v[72:75], a[0:3], v[136:139], v[72:75]
    v_mfma_f32_16x16x32_bf16 v[72:75], a[8:11], v[140:143], v[72:75]
    v_mfma_f32_16x16x32_bf16 v[76:79], a[4:7], v[136:139], v[76:79]
    ds_read_b128 v[136:139], v160 offset:12800
    v_mfma_f32_16x16x32_bf16 v[76:79], a[12:15], v[140:143], v[76:79]
    buffer_load_dwordx4 v164, s[24:27], s36 offen offset:1024 lds
    v_mfma_f32_16x16x32_bf16 v[80:83], a[0:3], v[140:143], v[80:83]
    v_mfma_f32_16x16x32_bf16 v[84:87], a[4:7], v[140:143], v[84:87]
    s_waitcnt lgkmcnt(2)
    v_mfma_f32_16x16x32_bf16 v[0:3], a[32:35], v[128:131], v[0:3]
    s_waitcnt lgkmcnt(1)
    s_xor_b32 s3, s52, 196608
    ds_read_b128 v[140:143], v160 offset:13824
    v_mfma_f32_16x16x32_bf16 v[0:3], a[40:43], v[132:135], v[0:3]
    s_add_u32 m0, s33, 12288
    s_add_u32 s36, s3, 524288
    v_mfma_f32_16x16x32_bf16 v[4:7], a[36:39], v[128:131], v[4:7]
    v_mfma_f32_16x16x32_bf16 v[4:7], a[44:47], v[132:135], v[4:7]
    buffer_load_dwordx4 v163, s[24:27], s36 offen lds
    v_mfma_f32_16x16x32_bf16 v[8:11], a[24:27], v[128:131], v[8:11]
    v_mfma_f32_16x16x32_bf16 v[8:11], a[32:35], v[132:135], v[8:11]
    s_waitcnt lgkmcnt(1)
    v_mfma_f32_16x16x32_bf16 v[8:11], a[40:43], v[136:139], v[8:11]
    v_mfma_f32_16x16x32_bf16 v[12:15], a[28:31], v[128:131], v[12:15]
    ds_read_b128 v[128:131], v160 offset:14848
    v_mfma_f32_16x16x32_bf16 v[12:15], a[36:39], v[132:135], v[12:15]
    v_mfma_f32_16x16x32_bf16 v[12:15], a[44:47], v[136:139], v[12:15]
    buffer_load_dwordx4 v164, s[24:27], s36 offen offset:1024 lds
    v_mfma_f32_16x16x32_bf16 v[16:19], a[24:27], v[132:135], v[16:19]
    v_mfma_f32_16x16x32_bf16 v[16:19], a[32:35], v[136:139], v[16:19]
    s_waitcnt lgkmcnt(1)
    v_mfma_f32_16x16x32_bf16 v[16:19], a[40:43], v[140:143], v[16:19]
    s_add_u32 m0, s33, 14336
    s_add_u32 s36, s3, 1048576
    v_mfma_f32_16x16x32_bf16 v[20:23], a[28:31], v[132:135], v[20:23]
    ds_read_b128 v[132:135], v160 offset:15872
    v_mfma_f32_16x16x32_bf16 v[20:23], a[36:39], v[136:139], v[20:23]
    v_mfma_f32_16x16x32_bf16 v[20:23], a[44:47], v[140:143], v[20:23]
    buffer_load_dwordx4 v163, s[24:27], s36 offen lds
    v_mfma_f32_16x16x32_bf16 v[24:27], a[24:27], v[136:139], v[24:27]
    v_mfma_f32_16x16x32_bf16 v[24:27], a[32:35], v[140:143], v[24:27]
    s_waitcnt lgkmcnt(1)
    v_mfma_f32_16x16x32_bf16 v[24:27], a[40:43], v[128:131], v[24:27]
    v_mfma_f32_16x16x32_bf16 v[28:31], a[28:31], v[136:139], v[28:31]
    ds_read_b128 v[136:139], v160 offset:16896
    v_mfma_f32_16x16x32_bf16 v[28:31], a[36:39], v[140:143], v[28:31]
    v_mfma_f32_16x16x32_bf16 v[28:31], a[44:47], v[128:131], v[28:31]
    buffer_load_dwordx4 v164, s[24:27], s36 offen offset:1024 lds
    v_mfma_f32_16x16x32_bf16 v[32:35], a[24:27], v[140:143], v[32:35]
    v_mfma_f32_16x16x32_bf16 v[32:35], a[32:35], v[128:131], v[32:35]
    s_waitcnt lgkmcnt(1)
    v_mfma_f32_16x16x32_bf16 v[32:35], a[40:43], v[132:135], v[32:35]
    s_add_u32 m0, s33, 16384
    s_add_u32 s36, s3, 0
    v_mfma_f32_16x16x32_bf16 v[36:39], a[28:31], v[140:143], v[36:39]
    ds_read_b128 v[140:143], v160 offset:17920
    v_mfma_f32_16x16x32_bf16 v[36:39], a[36:39], v[128:131], v[36:39]
    v_mfma_f32_16x16x32_bf16 v[36:39], a[44:47], v[132:135], v[36:39]
    buffer_load_dwordx4 v163, s[24:27], s36 offen lds
    v_mfma_f32_16x16x32_bf16 v[40:43], a[24:27], v[128:131], v[40:43]
    v_mfma_f32_16x16x32_bf16 v[40:43], a[32:35], v[132:135], v[40:43]
    s_waitcnt lgkmcnt(1)
    v_mfma_f32_16x16x32_bf16 v[40:43], a[40:43], v[136:139], v[40:43]
    v_mfma_f32_16x16x32_bf16 v[44:47], a[28:31], v[128:131], v[44:47]
    ds_read_b128 v[128:131], v160 offset:18944
    v_mfma_f32_16x16x32_bf16 v[44:47], a[36:39], v[132:135], v[44:47]
    s_waitcnt vmcnt(20)
    ds_read_b64_tr_b16 a[56:57], v161 offset:0
    v_mfma_f32_16x16x32_bf16 v[44:47], a[44:47], v[136:139], v[44:47]
    buffer_load_dwordx4 v164, s[24:27], s36 offen offset:1024 lds
    v_mfma_f32_16x16x32_bf16 v[48:51], a[24:27], v[132:135], v[48:51]
    ds_read_b64_tr_b16 a[58:59], v161 offset:256
    v_mfma_f32_16x16x32_bf16 v[48:51], a[32:35], v[136:139], v[48:51]
    s_waitcnt lgkmcnt(3)
    ds_read_b64_tr_b16 a[60:61], v161 offset:8
    v_mfma_f32_16x16x32_bf16 v[48:51], a[40:43], v[140:143], v[48:51]
    ds_read_b64_tr_b16 a[62:63], v161 offset:264
    v_mfma_f32_16x16x32_bf16 v[52:55], a[28:31], v[132:135], v[52:55]
    ds_read_b128 v[132:135], v160 offset:19968
    v_mfma_f32_16x16x32_bf16 v[52:55], a[36:39], v[136:139], v[52:55]
    s_waitcnt vmcnt(19)
    ds_read_b64_tr_b16 a[64:65], v161 offset:2048
    v_mfma_f32_16x16x32_bf16 v[52:55], a[44:47], v[140:143], v[52:55]
L_hop1:
    s_cmp_eq_u32 s54, 1
    s_cbranch_scc1 L_back
    v_mfma_f32_16x16x32_bf16 v[56:59], a[24:27], v[136:139], v[56:59]
    ds_read_b64_tr_b16 a[66:67], v161 offset:2304
    v_mfma_f32_16x16x32_bf16 v[56:59], a[32:35], v[140:143], v[56:59]
    s_waitcnt lgkmcnt(7)
    ds_read_b64_tr_b16 a[68:69], v161 offset:2056
    v_mfma_f32_16x16x32_bf16 v[56:59], a[40:43], v[128:131], v[56:59]
    ds_read_b64_tr_b16 a[70:71], v161 offset:2312
    v_mfma_f32_16x16x32_bf16 v[60:63], a[28:31], v[136:139], v[60:63]
    v_mfma_f32_16x16x32_bf16 v[60:63], a[36:39], v[140:143], v[60:63]
    s_waitcnt vmcnt(17)
    ds_read_b64_tr_b16 a[48:49], v161 offset:4096
    v_mfma_f32_16x16x32_bf16 v[60:63], a[44:47], v[128:131], v[60:63]
    v_mfma_f32_16x16x32_bf16 v[64:67], a[24:27], v[140:143], v[64:67]
    s_xor_b32 s3, s52, 229376
    s_add_u32 m0, s33, 0
    ds_read_b64_tr_b16 a[50:51], v161 offset:4352
    v_mfma_f32_16x16x32_bf16 v[64:67], a[32:35], v[128:131], v[64:67]
    s_waitcnt lgkmcnt(6)
    s_add_u32 s36, s3, 524288
    ds_read_b64_tr_b16 a[52:53], v161 offset:4104
    v_mfma_f32_16x16x32_bf16 v[64:67], a[40:43], v[132:135], v[64:67]
    s_waitcnt vmcnt(12)
    s_barrier
    ds_read_b64_tr_b16 a[54:55], v161 offset:4360
    v_mfma_f32_16x16x32_bf16 v[68:71], a[28:31], v[140:143], v[68:71]
    ds_read_b128 v[136:139], v160 offset:20480
    v_mfma_f32_16x16x32_bf16 v[68:71], a[36:39], v[128:131], v[68:71]
    ds_read_b128 v[140:143], v160 offset:21504
    v_mfma_f32_16x16x32_bf16 v[68:71], a[44:47], v[132:135], v[68:71]
    buffer_load_dwordx4 v163, s[24:27], s36 offen lds
    v_mfma_f32_16x16x32_bf16 v[72:75], a[24:27], v[128:131], v[72:75]
    v_mfma_f32_16x16x32_bf16 v[72:75], a[32:35], v[132:135], v[72:75]
    v_mfma_f32_16x16x32_bf16 v[76:79], a[28:31], v[128:131], v[76:79]
    ds_read_b128 v[128:131], v160 offset:22528
    v_mfma_f32_16x16x32_bf16 v[76:79], a[36:39], v[132:135], v[76:79]
    v_mfma_f32_16x16x32_bf16 v[80:83], a[24:27], v[132:135], v[80:83]
    v_mfma_f32_16x16x32_bf16 v[84:87], a[28:31], v[132:135], v[84:87]
    s_waitcnt lgkmcnt(3)
    s_waitcnt lgkmcnt(2)
    v_mfma_f32_16x16x32_bf16 v[0:3], a[56:59], v[136:139], v[0:3]
    s_waitcnt lgkmcnt(1)
    ds_read_b128 v[132:135], v160 offset:23552
    v_mfma_f32_16x16x32_bf16 v[0:3], a[64:67], v[140:143], v[0:3]
    buffer_load_dwordx4 v164, s[24:27], s36 offen offset:1024 lds
    v_mfma_f32_16x16x32_bf16 v[4:7], a[60:63], v[136:139], v[4:7]
    v_mfma_f32_16x16x32_bf16 v[4:7], a[68:71], v[140:143], v[4:7]
    v_mfma_f32_16x16x32_bf16 v[8:11], a[48:51], v[136:139], v[8:11]
    s_add_u32 m0, s34, 30720
    s_xor_b32 s37, s48, 384
    v_mfma_f32_16x16x32_bf16 v[8:11], a[56:59], v[140:143], v[8:11]
    s_waitcnt lgkmcnt(1)
    v_mfma_f32_16x16x32_bf16 v[8:11], a[64:67], v[128:131], v[8:11]
    v_mfma_f32_16x16x32_bf16 v[12:15], a[52:55], v[136:139], v[12:15]
    ds_read_b128 v[136:139], v160 offset:24576
    v_mfma_f32_16x16x32_bf16 v[12:15], a[60:63], v[140:143], v[12:15]
    buffer_load_dwordx4 v162, s[20:23], s37 offen lds
    v_mfma_f32_16x16x32_bf16 v[12:15], a[68:71], v[128:131], v[12:15]
    v_mfma_f32_16x16x32_bf16 v[16:19], a[48:51], v[140:143], v[16:19]
    v_mfma_f32_16x16x32_bf16 v[16:19], a[56:59], v[128:131], v[16:19]
    s_waitcnt lgkmcnt(1)
    v_mfma_f32_16x16x32_bf16 v[16:19], a[64:67], v[132:135], v[16:19]
    v_mfma_f32_16x16x32_bf16 v[20:23], a[52:55], v[140:143], v[20:23]
    ds_read_b128 v[140:143], v160 offset:25600
    v_mfma_f32_16x16x32_bf16 v[20:23], a[60:63], v[128:131], v[20:23]
    buffer_load_dwordx4 v162, s[20:23], s37 offen offset:2048 lds
    v_mfma_f32_16x16x32_bf16 v[20:23], a[68:71], v[132:135], v[20:23]
    v_mfma_f32_16x16x32_bf16 v[24:27], a[48:51], v[128:131], v[24:27]
    v_mfma_f32_16x16x32_bf16 v[24:27], a[56:59], v[132:135], v[24:27]
    s_waitcnt lgkmcnt(1)
    v_mfma_f32_16x16x32_bf16 v[24:27], a[64:67], v[136:139], v[24:27]
    s_add_u32 m0, s34, 34816
    s_xor_b32 s37, s48, 4480
    v_mfma_f32_16x16x32_bf16 v[28:31], a[52:55], v[128:131], v[28:31]
    ds_read_b128 v[128:131], v160 offset:26624
    v_mfma_f32_16x16x32_bf16 v[28:31], a[60:63], v[132:135], v[28:31]
    buffer_load_dwordx4 v162, s[20:23], s37 offen lds
    v_mfma_f32_16x16x32_bf16 v[28:31], a[68:71], v[136:139], v[28:31]
    v_mfma_f32_16x16x32_bf16 v[32:35], a[48:51], v[132:135], v[32:35]
    v_mfma_f32_16x16x32_bf16 v[32:35], a[56:59], v[136:139], v[32:35]
    s_waitcnt lgkmcnt(1)
    v_mfma_f32_16x16x32_bf16 v[32:35], a[64:67], v[140:143], v[32:35]
    v_mfma_f32_16x16x32_bf16 v[36:39], a[52:55], v[132:135], v[36:39]
    ds_read_b128 v[132:135], v160 offset:27648
    v_mfma_f32_16x16x32_bf16 v[36:39], a[60:63], v[136:139], v[36:39]
    buffer_load_dwordx4 v162, s[20:23], s37 offen offset:2048 lds
    v_mfma_f32_16x16x32_bf16 v[36:39], a[68:71], v[140:143], v[36:39]
    v_mfma_f32_16x16x32_bf16 v[40:43], a[48:51], v[136:139], v[40:43]
    v_mfma_f32_16x16x32_bf16 v[40:43], a[56:59], v[140:143], v[40:43]
    s_waitcnt lgkmcnt(1)
    v_mfma_f32_16x16x32_bf16 v[40:43], a[64:67], v[128:131], v[40:43]
    global_load_dwordx4 v[144:147], v156, s[10:11]
    v_mfma_f32_16x16x32_bf16 v[44:47], a[52:55], v[136:139], v[44:47]
    s_add_u32 m0, s34, 38912
    s_xor_b32 s37, s48, 8576
    ds_read_b128 v[136:139], v160 offset:28672
    v_mfma_f32_16x16x32_bf16 v[44:47], a[60:63], v[140:143], v[44:47]
    s_waitcnt vmcnt(17)
    ds_read_b64_tr_b16 a[80:81], v161 offset:6144
    v_mfma_f32_16x16x32_bf16 v[44:47], a[68:71], v[128:131], v[44:47]
    ds_read_b64_tr_b16 a[82:83], v161 offset:6400
    v_mfma_f32_16x16x32_bf16 v[48:51], a[48:51], v[140:143], v[48:51]
    ds_read_b64_tr_b16 a[84:85], v161 offset:6152
    v_mfma_f32_16x16x32_bf16 v[48:51], a[56:59], v[128:131], v[48:51]
    s_waitcnt lgkmcnt(4)
    buffer_load_dwordx4 v162, s[20:23], s37 offen lds
    v_mfma_f32_16x16x32_bf16 v[48:51], a[64:67], v[132:135], v[48:51]
    ds_read_b64_tr_b16 a[86:87], v161 offset:6408
    v_mfma_f32_16x16x32_bf16 v[52:55], a[52:55], v[140:143], v[52:55]
    ds_read_b128 v[140:143], v160 offset:29696
    v_mfma_f32_16x16x32_bf16 v[52:55], a[60:63], v[128:131], v[52:55]
    s_waitcnt vmcnt(16)
    s_add_u32 m0, s33, 2048
    ds_read_b64_tr_b16 a[88:89], v161 offset:8192
    v_mfma_f32_16x16x32_bf16 v[52:55], a[68:71], v[132:135], v[52:55]
    s_add_u32 s36, s3, 1048576
    ds_read_b64_tr_b16 a[90:91], v161 offset:8448
    v_mfma_f32_16x16x32_bf16 v[56:59], a[48:51], v[128:131], v[56:59]
    ds_read_b64_tr_b16 a[92:93], v161 offset:8200
    v_mfma_f32_16x16x32_bf16 v[56:59], a[56:59], v[132:135], v[56:59]
    s_waitcnt lgkmcnt(8)
    buffer_load_dwordx4 v163, s[24:27], s36 offen lds
    v_mfma_f32_16x16x32_bf16 v[56:59], a[64:67], v[136:139], v[56:59]
    ds_read_b64_tr_b16 a[94:95], v161 offset:8456
    v_mfma_f32_16x16x32_bf16 v[60:63], a[52:55], v[128:131], v[60:63]
    global_load_dwordx4 v[148:151], v156, s[12:13]
    v_mfma_f32_16x16x32_bf16 v[60:63], a[60:63], v[132:135], v[60:63]
    s_waitcnt vmcnt(16)
    ds_read_b64_tr_b16 a[72:73], v161 offset:10240
    v_mfma_f32_16x16x32_bf16 v[60:63], a[68:71], v[136:139], v[60:63]
    ds_read_b64_tr_b16 a[74:75], v161 offset:10496
    v_mfma_f32_16x16x32_bf16 v[64:67], a[48:51], v[132:135], v[64:67]
    ds_read_b128 v[128:131], v160 offset:20992
    v_mfma_f32_16x16x32_bf16 v[64:67], a[56:59], v[136:139], v[64:67]
    s_waitcnt lgkmcnt(7)
    buffer_load_dwordx4 v164, s[24:27], s36 offen offset:1024 lds
    v_mfma_f32_16x16x32_bf16 v[64:67], a[64:67], v[140:143], v[64:67]
    ds_read_b64_tr_b16 a[76:77], v161 offset:10248
    v_mfma_f32_16x16x32_bf16 v[68:71], a[52:55], v[132:135], v[68:71]
    ds_read_b128 v[132:135], v160 offset:22016
    v_mfma_f32_16x16x32_bf16 v[68:71], a[60:63], v[136:139], v[68:71]
    s_add_u32 m0, s33, 4096
    s_add_u32 s36, s3, 0
    ds_read_b64_tr_b16 a[78:79], v161 offset:10504
    v_mfma_f32_16x16x32_bf16 v[68:71], a[68:71], v[140:143], v[68:71]
    v_mfma_f32_16x16x32_bf16 v[72:75], a[48:51], v[136:139], v[72:75]
    v_mfma_f32_16x16x32_bf16 v[72:75], a[56:59], v[140:143], v[72:75]
    buffer_load_dwordx4 v163, s[24:27], s36 offen lds
    v_mfma_f32_16x16x32_bf16 v[76:79], a[52:55], v[136:139], v[76:79]
    ds_read_b128 v[136:139], v160 offset:23040
    v_mfma_f32_16x16x32_bf16 v[76:79], a[60:63], v[140:143], v[76:79]
    global_load_dwordx4 v[152:155], v156, s[8:9]
    v_mfma_f32_16x16x32_bf16 v[80:83], a[48:51], v[140:143], v[80:83]
    v_mfma_f32_16x16x32_bf16 v[84:87], a[52:55], v[140:143], v[84:87]
    s_waitcnt lgkmcnt(1)
    v_mfma_f32_16x16x32_bf16 v[0:3], a[80:83], v[128:131], v[0:3]
    ds_read_b128 v[140:143], v160 offset:24064
    v_mfma_f32_16x16x32_bf16 v[0:3], a[88:91], v[132:135], v[0:3]
    buffer_load_dwordx4 v164, s[24:27], s36 offen offset:1024 lds
    v_mfma_f32_16x16x32_bf16 v[4:7], a[84:87], v[128:131], v[4:7]
    v_mfma_f32_16x16x32_bf16 v[4:7], a[92:95], v[132:135], v[4:7]
    v_mfma_f32_16x16x32_bf16 v[8:11], a[72:75], v[128:131], v[8:11]
    s_xor_b32 s3, s52, 262144
    s_add_u32 m0, s33, 6144
    s_add_u32 s36, s3, 524288
    v_mfma_f32_16x16x32_bf16 v[8:11], a[80:83], v[132:135], v[8:11]
    s_waitcnt lgkmcnt(1)
    v_mfma_f32_16x16x32_bf16 v[8:11], a[88:91], v[136:139], v[8:11]
    v_mfma_f32_16x16x32_bf16 v[12:15], a[76:79], v[128:131], v[12:15]
    buffer_load_dwordx4 v163, s[24:27], s36 offen lds
    v_mfma_f32_16x16x32_bf16 v[12:15], a[84:87], v[132:135], v[12:15]
    ds_read_b128 v[128:131], v160 offset:25088
    v_mfma_f32_16x16x32_bf16 v[12:15], a[92:95], v[136:139], v[12:15]
    global_load_dwordx4 v[156:159], v156, s[14:15]
    v_mfma_f32_16x16x32_bf16 v[16:19], a[72:75], v[132:135], v[16:19]
    v_mfma_f32_16x16x32_bf16 v[16:19], a[80:83], v[136:139], v[16:19]
    s_waitcnt lgkmcnt(1)
    v_mfma_f32_16x16x32_bf16 v[16:19], a[88:91], v[140:143], v[16:19]
    v_mfma_f32_16x16x32_bf16 v[20:23], a[76:79], v[132:135], v[20:23]
    buffer_load_dwordx4 v164, s[24:27], s36 offen offset:1024 lds
    v_mfma_f32_16x16x32_bf16 v[20:23], a[84:87], v[136:139], v[20:23]
    ds_read_b128 v[132:135], v160 offset:26112
    v_mfma_f32_16x16x32_bf16 v[20:23], a[92:95], v[140:143], v[20:23]
    v_mfma_f32_16x16x32_bf16 v[24:27], a[72:75], v[136:139], v[24:27]
    s_add_u32 m0, s33, 8192
    s_add_u32 s36, s3, 1048576
    v_mfma_f32_16x16x32_bf16 v[24:27], a[80:83], v[140:143], v[24:27]
    s_waitcnt lgkmcnt(1)
    v_mfma_f32_16x16x32_bf16 v[24:27], a[88:91], v[128:131], v[24:27]
    v_mfma_f32_16x16x32_bf16 v[28:31], a[76:79], v[136:139], v[28:31]
    buffer_load_dwordx4 v163, s[24:27], s36 offen lds
    v_mfma_f32_16x16x32_bf16 v[28:31], a[84:87], v[140:143], v[28:31]
    ds_read_b128 v[136:139], v160 offset:27136
    v_mfma_f32_16x16x32_bf16 v[28:31], a[92:95], v[128:131], v[28:31]
    v_mfma_f32_16x16x32_bf16 v[32:35], a[72:75], v[140:143], v[32:35]
    v_mfma_f32_16x16x32_bf16 v[32:35], a[80:83], v[128:131], v[32:35]
    s_waitcnt lgkmcnt(1)
    v_mfma_f32_16x16x32_bf16 v[32:35], a[88:91], v[132:135], v[32:35]
    v_mfma_f32_16x16x32_bf16 v[36:39], a[76:79], v[140:143], v[36:39]
    buffer_load_dwordx4 v164, s[24:27], s36 offen offset:1024 lds
    v_mfma_f32_16x16x32_bf16 v[36:39], a[84:87], v[128:131], v[36:39]
    ds_read_b128 v[140:143], v160 offset:28160
    v_mfma_f32_16x16x32_bf16 v[36:39], a[92:95], v[132:135], v[36:39]
    v_mfma_f32_16x16x32_bf16 v[40:43], a[72:75], v[128:131], v[40:43]
    s_add_u32 m0, s33, 10240
    s_add_u32 s36, s3, 0
    v_mfma_f32_16x16x32_bf16 v[40:43], a[80:83], v[132:135], v[40:43]
    s_waitcnt lgkmcnt(1)
    v_mfma_f32_16x16x32_bf16 v[40:43], a[88:91], v[136:139], v[40:43]
    v_mfma_f32_16x16x32_bf16 v[44:47], a[76:79], v[128:131], v[44:47]
    buffer_load_dwordx4 v163, s[24:27], s36 offen lds
    v_mfma_f32_16x16x32_bf16 v[44:47], a[84:87], v[132:135], v[44:47]
    s_waitcnt vmcnt(24)
    ds_read_b128 v[128:131], v160 offset:29184
    v_mfma_f32_16x16x32_bf16 v[44:47], a[92:95], v[136:139], v[44:47]
    ds_read_b64_tr_b16 a[104:105], v161 offset:12288
    v_mfma_f32_16x16x32_bf16 v[48:51], a[72:75], v[132:135], v[48:51]
    ds_read_b64_tr_b16 a[106:107], v161 offset:12544
    v_mfma_f32_16x16x32_bf16 v[48:51], a[80:83], v[136:139], v[48:51]
    s_waitcnt lgkmcnt(3)
    ds_read_b64_tr_b16 a[108:109], v161 offset:12296
    v_mfma_f32_16x16x32_bf16 v[48:51], a[88:91], v[140:143], v[48:51]
    ds_read_b64_tr_b16 a[110:111], v161 offset:12552
    v_mfma_f32_16x16x32_bf16 v[52:55], a[76:79], v[132:135], v[52:55]
    buffer_load_dwordx4 v164, s[24:27], s36 offen offset:1024 lds
    v_mfma_f32_16x16x32_bf16 v[52:55], a[84:87], v[136:139], v[52:55]
    s_waitcnt vmcnt(23)
    ds_read_b128 v[132:135], v160 offset:30208
    v_mfma_f32_16x16x32_bf16 v[52:55], a[92:95], v[140:143], v[52:55]
    ds_read_b64_tr_b16 a[112:113], v161 offset:14336
    v_mfma_f32_16x16x32_bf16 v[56:59], a[72:75], v[136:139], v[56:59]
    s_add_u32 m0, s34, 0
    s_xor_b32 s37, s48, 512
    ds_read_b64_tr_b16 a[114:115], v161 offset:14592
    v_mfma_f32_16x16x32_bf16 v[56:59], a[80:83], v[140:143], v[56:59]
    s_waitcnt lgkmcnt(7)
    ds_read_b64_tr_b16 a[116:117], v161 offset:14344
    v_mfma_f32_16x16x32_bf16 v[56:59], a[88:91], v[128:131], v[56:59]
    ds_read_b64_tr_b16 a[118:119], v161 offset:14600
    v_mfma_f32_16x16x32_bf16 v[60:63], a[76:79], v[136:139], v[60:63]
    buffer_load_dwordx4 v162, s[20:23], s37 offen lds
    v_mfma_f32_16x16x32_bf16 v[60:63], a[84:87], v[140:143], v[60:63]
    s_waitcnt vmcnt(22)
    ds_read_b64_tr_b16 a[96:97], v161 offset:16384
    v_mfma_f32_16x16x32_bf16 v[60:63], a[92:95], v[128:131], v[60:63]
    ds_read_b64_tr_b16 a[98:99], v161 offset:16640
    v_mfma_f32_16x16x32_bf16 v[64:67], a[72:75], v[140:143], v[64:67]
    ds_read_b64_tr_b16 a[100:101], v161 offset:16392
    v_mfma_f32_16x16x32_bf16 v[64:67], a[80:83], v[128:131], v[64:67]
    s_waitcnt lgkmcnt(7)
    ds_read_b64_tr_b16 a[102:103], v161 offset:16648
    v_mfma_f32_16x16x32_bf16 v[64:67], a[88:91], v[132:135], v[64:67]
    s_waitcnt vmcnt(14)
    s_barrier
    v_mfma_f32_16x16x32_bf16 v[68:71], a[76:79], v[140:143], v[68:71]
    buffer_load_dwordx4 v162, s[20:23], s37 offen offset:2048 lds
    v_mfma_f32_16x16x32_bf16 v[68:71], a[84:87], v[128:131], v[68:71]
    ds_read_b128 v[136:139], v160 offset:30720
    v_mfma_f32_16x16x32_bf16 v[68:71], a[92:95], v[132:135], v[68:71]
    ds_read_b128 v[140:143], v160 offset:31744
    v_mfma_f32_16x16x32_bf16 v[72:75], a[72:75], v[128:131], v[72:75]
    s_add_u32 m0, s34, 4096
    s_xor_b32 s37, s48, 4608
    v_mfma_f32_16x16x32_bf16 v[72:75], a[80:83], v[132:135], v[72:75]
    v_mfma_f32_16x16x32_bf16 v[76:79], a[76:79], v[128:131], v[76:79]
    ds_read_b128 v[128:131], v160 offset:32768
    v_mfma_f32_16x16x32_bf16 v[76:79], a[84:87], v[132:135], v[76:79]
    buffer_load_dwordx4 v162, s[20:23], s37 offen lds
    v_mfma_f32_16x16x32_bf16 v[80:83], a[72:75], v[132:135], v[80:83]
    v_mfma_f32_16x16x32_bf16 v[84:87], a[76:79], v[132:135], v[84:87]
    s_waitcnt lgkmcnt(3)
    s_waitcnt lgkmcnt(2)
    v_mfma_f32_16x16x32_bf16 v[0:3], a[104:107], v[136:139], v[0:3]
    s_waitcnt lgkmcnt(1)
    ds_read_b128 v[132:135], v160 offset:33792
    v_mfma_f32_16x16x32_bf16 v[0:3], a[112:115], v[140:143], v[0:3]
    v_mfma_f32_16x16x32_bf16 v[4:7], a[108:111], v[136:139], v[4:7]
    v_mfma_f32_16x16x32_bf16 v[4:7], a[116:119], v[140:143], v[4:7]
    buffer_load_dwordx4 v162, s[20:23], s37 offen offset:2048 lds
    v_mfma_f32_16x16x32_bf16 v[8:11], a[96:99], v[136:139], v[8:11]
    v_mfma_f32_16x16x32_bf16 v[8:11], a[104:107], v[140:143], v[8:11]
    s_waitcnt lgkmcnt(1)
    v_mfma_f32_16x16x32_bf16 v[8:11], a[112:115], v[128:131], v[8:11]
    s_add_u32 m0, s34, 8192
    s_xor_b32 s37, s48, 8704
    v_mfma_f32_16x16x32_bf16 v[12:15], a[100:103], v[136:139], v[12:15]
    ds_read_b128 v[136:139], v160 offset:34816
    v_mfma_f32_16x16x32_bf16 v[12:15], a[108:111], v[140:143], v[12:15]
    v_mfma_f32_16x16x32_bf16 v[12:15], a[116:119], v[128:131], v[12:15]
    buffer_load_dwordx4 v162, s[20:23], s37 offen lds
    v_mfma_f32_16x16x32_bf16 v[16:19], a[96:99], v[140:143], v[16:19]
    v_mfma_f32_16x16x32_bf16 v[16:19], a[104:107], v[128:131], v[16:19]
    s_waitcnt lgkmcnt(1)
    v_mfma_f32_16x16x32_bf16 v[16:19], a[112:115], v[132:135], v[16:19]
    s_xor_b32 s3, s52, 294912
    s_add_u32 m0, s33, 12288
    s_add_u32 s36, s3, 524288
    v_mfma_f32_16x16x32_bf16 v[20:23], a[100:103], v[140:143], v[20:23]
    ds_read_b128 v[140:143], v160 offset:35840
    v_mfma_f32_16x16x32_bf16 v[20:23], a[108:111], v[128:131], v[20:23]
    v_mfma_f32_16x16x32_bf16 v[20:23], a[116:119], v[132:135], v[20:23]
    buffer_load_dwordx4 v163, s[24:27], s36 offen lds
    v_mfma_f32_16x16x32_bf16 v[24:27], a[96:99], v[128:131], v[24:27]
    v_mfma_f32_16x16x32_bf16 v[24:27], a[104:107], v[132:135], v[24:27]
    s_waitcnt lgkmcnt(1)
    v_mfma_f32_16x16x32_bf16 v[24:27], a[112:115], v[136:139], v[24:27]
    v_mfma_f32_16x16x32_bf16 v[28:31], a[100:103], v[128:131], v[28:31]
    ds_read_b128 v[128:131], v160 offset:36864
    v_mfma_f32_16x16x32_bf16 v[28:31], a[108:111], v[132:135], v[28:31]
    v_mfma_f32_16x16x32_bf16 v[28:31], a[116:119], v[136:139], v[28:31]
    buffer_load_dwordx4 v164, s[24:27], s36 offen offset:1024 lds
    v_mfma_f32_16x16x32_bf16 v[32:35], a[96:99], v[132:135], v[32:35]
    v_mfma_f32_16x16x32_bf16 v[32:35], a[104:107], v[136:139], v[32:35]
    s_waitcnt lgkmcnt(1)
    v_mfma_f32_16x16x32_bf16 v[32:35], a[112:115], v[140:143], v[32:35]
    s_add_u32 m0, s33, 14336
    s_add_u32 s36, s3, 1048576
    v_mfma_f32_16x16x32_bf16 v[36:39], a[100:103], v[132:135], v[36:39]
    ds_read_b128 v[132:135], v160 offset:37888
    v_mfma_f32_16x16x32_bf16 v[36:39], a[108:111], v[136:139], v[36:39]
    v_mfma_f32_16x16x32_bf16 v[36:39], a[116:119], v[140:143], v[36:39]
    buffer_load_dwordx4 v163, s[24:27], s36 offen lds
    v_mfma_f32_16x16x32_bf16 v[40:43], a[96:99], v[136:139], v[40:43]
    v_mfma_f32_16x16x32_bf16 v[40:43], a[104:107], v[140:143], v[40:43]
    s_waitcnt lgkmcnt(1)
    v_mfma_f32_16x16x32_bf16 v[40:43], a[112:115], v[128:131], v[40:43]
    v_mfma_f32_16x16x32_bf16 v[44:47], a[100:103], v[136:139], v[44:47]
    ds_read_b128 v[136:139], v160 offset:38912
    v_mfma_f32_16x16x32_bf16 v[44:47], a[108:111], v[140:143], v[44:47]
    ds_read_b64_tr_b16 a[128:129], v161 offset:0
    v_mfma_f32_16x16x32_bf16 v[44:47], a[116:119], v[128:131], v[44:47]
    buffer_load_dwordx4 v164, s[24:27], s36 offen offset:1024 lds
    v_mfma_f32_16x16x32_bf16 v[48:51], a[96:99], v[140:143], v[48:51]
    ds_read_b64_tr_b16 a[130:131], v161 offset:256
    v_mfma_f32_16x16x32_bf16 v[48:51], a[104:107], v[128:131], v[48:51]
    s_waitcnt lgkmcnt(3)
    ds_read_b64_tr_b16 a[132:133], v161 offset:8
    v_mfma_f32_16x16x32_bf16 v[48:51], a[112:115], v[132:135], v[48:51]
    s_add_u32 m0, s33, 16384
    s_add_u32 s36, s3, 0
    ds_read_b64_tr_b16 a[134:135], v161 offset:264
    v_mfma_f32_16x16x32_bf16 v[52:55], a[100:103], v[140:143], v[52:55]
    ds_read_b128 v[140:143], v160 offset:39936
    v_mfma_f32_16x16x32_bf16 v[52:55], a[108:111], v[128:131], v[52:55]
    s_waitcnt vmcnt(19)
    ds_read_b64_tr_b16 a[136:137], v161 offset:2048
    v_mfma_f32_16x16x32_bf16 v[52:55], a[116:119], v[132:135], v[52:55]
    buffer_load_dwordx4 v163, s[24:27], s36 offen lds
    v_mfma_f32_16x16x32_bf16 v[56:59], a[96:99], v[128:131], v[56:59]
    ds_read_b64_tr_b16 a[138:139], v161 offset:2304
    v_mfma_f32_16x16x32_bf16 v[56:59], a[104:107], v[132:135], v[56:59]
    s_waitcnt lgkmcnt(7)
    ds_read_b64_tr_b16 a[140:141], v161 offset:2056
    v_mfma_f32_16x16x32_bf16 v[56:59], a[112:115], v[136:139], v[56:59]
    ds_read_b64_tr_b16 a[142:143], v161 offset:2312
    v_mfma_f32_16x16x32_bf16 v[60:63], a[100:103], v[128:131], v[60:63]
    v_mfma_f32_16x16x32_bf16 v[60:63], a[108:111], v[132:135], v[60:63]
    s_waitcnt vmcnt(17)
    ds_read_b64_tr_b16 a[120:121], v161 offset:4096
    v_mfma_f32_16x16x32_bf16 v[60:63], a[116:119], v[136:139], v[60:63]
    buffer_load_dwordx4 v164, s[24:27], s36 offen offset:1024 lds
    v_mfma_f32_16x16x32_bf16 v[64:67], a[96:99], v[132:135], v[64:67]
    ds_read_b128 v[128:131], v160 offset:31232
    v_mfma_f32_16x16x32_bf16 v[64:67], a[104:107], v[136:139], v[64:67]
    s_waitcnt lgkmcnt(6)
    ds_read_b64_tr_b16 a[122:123], v161 offset:4352
    v_mfma_f32_16x16x32_bf16 v[64:67], a[112:115], v[140:143], v[64:67]
    s_xor_b32 s3, s52, 327680
    s_add_u32 m0, s33, 0
    ds_read_b64_tr_b16 a[124:125], v161 offset:4104
    v_mfma_f32_16x16x32_bf16 v[68:71], a[100:103], v[132:135], v[68:71]
    s_add_u32 s36, s3, 524288
    ds_read_b128 v[132:135], v160 offset:32256
    v_mfma_f32_16x16x32_bf16 v[68:71], a[108:111], v[136:139], v[68:71]
    ds_read_b64_tr_b16 a[126:127], v161 offset:4360
    v_mfma_f32_16x16x32_bf16 v[68:71], a[116:119], v[140:143], v[68:71]
    buffer_load_dwordx4 v163, s[24:27], s36 offen lds
    v_mfma_f32_16x16x32_bf16 v[72:75], a[96:99], v[136:139], v[72:75]
    v_mfma_f32_16x16x32_bf16 v[72:75], a[104:107], v[140:143], v[72:75]
    v_mfma_f32_16x16x32_bf16 v[76:79], a[100:103], v[136:139], v[76:79]
    ds_read_b128 v[136:139], v160 offset:33280
    v_mfma_f32_16x16x32_bf16 v[76:79], a[108:111], v[140:143], v[76:79]
    v_mfma_f32_16x16x32_bf16 v[80:83], a[96:99], v[140:143], v[80:83]
    v_mfma_f32_16x16x32_bf16 v[84:87], a[100:103], v[140:143], v[84:87]
    s_waitcnt lgkmcnt(1)
    v_mfma_f32_16x16x32_bf16 v[0:3], a[128:131], v[128:131], v[0:3]
    ds_read_b128 v[140:143], v160 offset:34304
    v_mfma_f32_16x16x32_bf16 v[0:3], a[136:139], v[132:135], v[0:3]
    buffer_load_dwordx4 v164, s[24:27], s36 offen offset:1024 lds
    v_mfma_f32_16x16x32_bf16 v[4:7], a[132:135], v[128:131], v[4:7]
    v_mfma_f32_16x16x32_bf16 v[4:7], a[140:143], v[132:135], v[4:7]
    v_mfma_f32_16x16x32_bf16 v[8:11], a[120:123], v[128:131], v[8:11]
    s_add_u32 m0, s33, 2048
    s_add_u32 s36, s3, 1048576
    v_mfma_f32_16x16x32_bf16 v[8:11], a[128:131], v[132:135], v[8:11]
    s_waitcnt lgkmcnt(1)
    v_mfma_f32_16x16x32_bf16 v[8:11], a[136:139], v[136:139], v[8:11]
    v_mfma_f32_16x16x32_bf16 v[12:15], a[124:127], v[128:131], v[12:15]
    ds_read_b128 v[128:131], v160 offset:35328
    v_mfma_f32_16x16x32_bf16 v[12:15], a[132:135], v[132:135], v[12:15]
    buffer_load_dwordx4 v163, s[24:27], s36 offen lds
    v_mfma_f32_16x16x32_bf16 v[12:15], a[140:143], v[136:139], v[12:15]
    v_mfma_f32_16x16x32_bf16 v[16:19], a[120:123], v[132:135], v[16:19]
    v_mfma_f32_16x16x32_bf16 v[16:19], a[128:131], v[136:139], v[16:19]
    s_waitcnt lgkmcnt(1)
    v_mfma_f32_16x16x32_bf16 v[16:19], a[136:139], v[140:143], v[16:19]
    v_mfma_f32_16x16x32_bf16 v[20:23], a[124:127], v[132:135], v[20:23]
    ds_read_b128 v[132:135], v160 offset:36352
    v_mfma_f32_16x16x32_bf16 v[20:23], a[132:135], v[136:139], v[20:23]
    buffer_load_dwordx4 v164, s[24:27], s36 offen offset:1024 lds
    v_mfma_f32_16x16x32_bf16 v[20:23], a[140:143], v[140:143], v[20:23]
    v_mfma_f32_16x16x32_bf16 v[24:27], a[120:123], v[136:139], v[24:27]
    v_mfma_f32_16x16x32_bf16 v[24:27], a[128:131], v[140:143], v[24:27]
    s_waitcnt lgkmcnt(1)
    v_mfma_f32_16x16x32_bf16 v[24:27], a[136:139], v[128:131], v[24:27]
    s_add_u32 m0, s33, 4096
    s_add_u32 s36, s3, 0
    v_mfma_f32_16x16x32_bf16 v[28:31], a[124:127], v[136:139], v[28:31]
    ds_read_b128 v[136:139], v160 offset:37376
    v_mfma_f32_16x16x32_bf16 v[28:31], a[132:135], v[140:143], v[28:31]
    buffer_load_dwordx4 v163, s[24:27], s36 offen lds
    v_mfma_f32_16x16x32_bf16 v[28:31], a[140:143], v[128:131], v[28:31]
    v_mfma_f32_16x16x32_bf16 v[32:35], a[120:123], v[140:143], v[32:35]
    v_mfma_f32_16x16x32_bf16 v[32:35], a[128:131], v[128:131], v[32:35]
    s_waitcnt lgkmcnt(1)
    v_mfma_f32_16x16x32_bf16 v[32:35], a[136:139], v[132:135], v[32:35]
    v_mfma_f32_16x16x32_bf16 v[36:39], a[124:127], v[140:143], v[36:39]
    ds_read_b128 v[140:143], v160 offset:38400
    v_mfma_f32_16x16x32_bf16 v[36:39], a[132:135], v[128:131], v[36:39]
    buffer_load_dwordx4 v164, s[24:27], s36 offen offset:1024 lds
    v_mfma_f32_16x16x32_bf16 v[36:39], a[140:143], v[132:135], v[36:39]
    v_mfma_f32_16x16x32_bf16 v[40:43], a[120:123], v[128:131], v[40:43]
    v_mfma_f32_16x16x32_bf16 v[40:43], a[128:131], v[132:135], v[40:43]
    s_waitcnt lgkmcnt(1)
    v_mfma_f32_16x16x32_bf16 v[40:43], a[136:139], v[136:139], v[40:43]
    s_add_u32 m0, s34, 10240
    s_xor_b32 s37, s48, 640
    v_mfma_f32_16x16x32_bf16 v[44:47], a[124:127], v[128:131], v[44:47]
    ds_read_b128 v[128:131], v160 offset:39424
    v_mfma_f32_16x16x32_bf16 v[44:47], a[132:135], v[132:135], v[44:47]
    s_waitcnt vmcnt(21)
    ds_read_b64_tr_b16 a[152:153], v161 offset:6144
    v_mfma_f32_16x16x32_bf16 v[44:47], a[140:143], v[136:139], v[44:47]
    ds_read_b64_tr_b16 a[154:155], v161 offset:6400
    v_mfma_f32_16x16x32_bf16 v[48:51], a[120:123], v[132:135], v[48:51]
    ds_read_b64_tr_b16 a[156:157], v161 offset:6152
    v_mfma_f32_16x16x32_bf16 v[48:51], a[128:131], v[136:139], v[48:51]
    s_waitcnt lgkmcnt(4)
    buffer_load_dwordx4 v162, s[20:23], s37 offen lds
    v_mfma_f32_16x16x32_bf16 v[48:51], a[136:139], v[140:143], v[48:51]
    ds_read_b64_tr_b16 a[158:159], v161 offset:6408
    v_mfma_f32_16x16x32_bf16 v[52:55], a[124:127], v[132:135], v[52:55]
    ds_read_b128 v[132:135], v160 offset:40448
    v_mfma_f32_16x16x32_bf16 v[52:55], a[132:135], v[136:139], v[52:55]
    s_waitcnt vmcnt(20)
    ds_read_b64_tr_b16 a[160:161], v161 offset:8192
    v_mfma_f32_16x16x32_bf16 v[52:55], a[140:143], v[140:143], v[52:55]
    ds_read_b64_tr_b16 a[162:163], v161 offset:8448
    v_mfma_f32_16x16x32_bf16 v[56:59], a[120:123], v[136:139], v[56:59]
    ds_read_b64_tr_b16 a[164:165], v161 offset:8200
    v_mfma_f32_16x16x32_bf16 v[56:59], a[128:131], v[140:143], v[56:59]
    s_waitcnt lgkmcnt(8)
    buffer_load_dwordx4 v162, s[20:23], s37 offen offset:2048 lds
    v_mfma_f32_16x16x32_bf16 v[56:59], a[136:139], v[128:131], v[56:59]
    ds_read_b64_tr_b16 a[166:167], v161 offset:8456
    v_mfma_f32_16x16x32_bf16 v[60:63], a[124:127], v[136:139], v[60:63]
    v_mfma_f32_16x16x32_bf16 v[60:63], a[132:135], v[140:143], v[60:63]
    s_waitcnt vmcnt(19)
    s_add_u32 m0, s34, 14336
    ds_read_b64_tr_b16 a[144:145], v161 offset:10240
    v_mfma_f32_16x16x32_bf16 v[60:63], a[140:143], v[128:131], v[60:63]
    s_xor_b32 s37, s48, 4736
    ds_read_b64_tr_b16 a[146:147], v161 offset:10496
    v_mfma_f32_16x16x32_bf16 v[64:67], a[120:123], v[140:143], v[64:67]
    ds_read_b64_tr_b16 a[148:149], v161 offset:10248
    v_mfma_f32_16x16x32_bf16 v[64:67], a[128:131], v[128:131], v[64:67]
    s_waitcnt lgkmcnt(7)
    buffer_load_dwordx4 v162, s[20:23], s37 offen lds
    v_mfma_f32_16x16x32_bf16 v[64:67], a[136:139], v[132:135], v[64:67]
    s_waitcnt vmcnt(15)
    s_barrier
    ds_read_b64_tr_b16 a[150:151], v161 offset:10504
    v_mfma_f32_16x16x32_bf16 v[68:71], a[124:127], v[140:143], v[68:71]
    ds_read_b128 v[136:139], v160 offset:0
    v_mfma_f32_16x16x32_bf16 v[68:71], a[132:135], v[128:131], v[68:71]
    ds_read_b128 v[140:143], v160 offset:1024
    v_mfma_f32_16x16x32_bf16 v[68:71], a[140:143], v[132:135], v[68:71]
    v_mfma_f32_16x16x32_bf16 v[72:75], a[120:123], v[128:131], v[72:75]
    v_mfma_f32_16x16x32_bf16 v[72:75], a[128:131], v[132:135], v[72:75]
    buffer_load_dwordx4 v162, s[20:23], s37 offen offset:2048 lds
    v_mfma_f32_16x16x32_bf16 v[76:79], a[124:127], v[128:131], v[76:79]
    ds_read_b128 v[128:131], v160 offset:2048
    v_mfma_f32_16x16x32_bf16 v[76:79], a[132:135], v[132:135], v[76:79]
    v_mfma_f32_16x16x32_bf16 v[80:83], a[120:123], v[132:135], v[80:83]
    s_add_u32 m0, s34, 18432
    s_xor_b32 s37, s48, 8832
    v_mfma_f32_16x16x32_bf16 v[84:87], a[124:127], v[132:135], v[84:87]
    s_waitcnt lgkmcnt(3)
    s_waitcnt lgkmcnt(2)
    v_mfma_f32_16x16x32_bf16 v[0:3], a[152:155], v[136:139], v[0:3]
    s_waitcnt lgkmcnt(1)
    ds_read_b128 v[132:135], v160 offset:3072
    v_mfma_f32_16x16x32_bf16 v[0:3], a[160:163], v[140:143], v[0:3]
    buffer_load_dwordx4 v162, s[20:23], s37 offen lds
    v_mfma_f32_16x16x32_bf16 v[4:7], a[156:159], v[136:139], v[4:7]
    v_mfma_f32_16x16x32_bf16 v[4:7], a[164:167], v[140:143], v[4:7]
    v_mfma_f32_16x16x32_bf16 v[8:11], a[144:147], v[136:139], v[8:11]
    s_xor_b32 s3, s52, 360448
    s_add_u32 m0, s33, 6144
    s_add_u32 s36, s3, 524288
    v_mfma_f32_16x16x32_bf16 v[8:11], a[152:155], v[140:143], v[8:11]
    s_waitcnt lgkmcnt(1)
    v_mfma_f32_16x16x32_bf16 v[8:11], a[160:163], v[128:131], v[8:11]
    v_mfma_f32_16x16x32_bf16 v[12:15], a[148:151], v[136:139], v[12:15]
    buffer_load_dwordx4 v163, s[24:27], s36 offen lds
    v_mfma_f32_16x16x32_bf16 v[12:15], a[156:159], v[140:143], v[12:15]
    ds_read_b128 v[136:139], v160 offset:4096
    v_mfma_f32_16x16x32_bf16 v[12:15], a[164:167], v[128:131], v[12:15]
    v_mfma_f32_16x16x32_bf16 v[16:19], a[144:147], v[140:143], v[16:19]
    v_mfma_f32_16x16x32_bf16 v[16:19], a[152:155], v[128:131], v[16:19]
    s_waitcnt lgkmcnt(1)
    v_mfma_f32_16x16x32_bf16 v[16:19], a[160:163], v[132:135], v[16:19]
    v_mfma_f32_16x16x32_bf16 v[20:23], a[148:151], v[140:143], v[20:23]
    buffer_load_dwordx4 v164, s[24:27], s36 offen offset:1024 lds
    v_mfma_f32_16x16x32_bf16 v[20:23], a[156:159], v[128:131], v[20:23]
    ds_read_b128 v[140:143], v160 offset:5120
    v_mfma_f32_16x16x32_bf16 v[20:23], a[164:167], v[132:135], v[20:23]
    v_mfma_f32_16x16x32_bf16 v[24:27], a[144:147], v[128:131], v[24:27]
    s_add_u32 m0, s33, 8192
    s_add_u32 s36, s3, 1048576
    v_mfma_f32_16x16x32_bf16 v[24:27], a[152:155], v[132:135], v[24:27]
    s_waitcnt lgkmcnt(1)
    v_mfma_f32_16x16x32_bf16 v[24:27], a[160:163], v[136:139], v[24:27]
    v_mfma_f32_16x16x32_bf16 v[28:31], a[148:151], v[128:131], v[28:31]
    buffer_load_dwordx4 v163, s[24:27], s36 offen lds
    v_mfma_f32_16x16x32_bf16 v[28:31], a[156:159], v[132:135], v[28:31]
    ds_read_b128 v[128:131], v160 offset:6144
    v_mfma_f32_16x16x32_bf16 v[28:31], a[164:167], v[136:139], v[28:31]
    v_mfma_f32_16x16x32_bf16 v[32:35], a[144:147], v[132:135], v[32:35]
    v_mfma_f32_16x16x32_bf16 v[32:35], a[152:155], v[136:139], v[32:35]
    s_waitcnt lgkmcnt(1)
    v_mfma_f32_16x16x32_bf16 v[32:35], a[160:163], v[140:143], v[32:35]
    v_mfma_f32_16x16x32_bf16 v[36:39], a[148:151], v[132:135], v[36:39]
    buffer_load_dwordx4 v164, s[24:27], s36 offen offset:1024 lds
    v_mfma_f32_16x16x32_bf16 v[36:39], a[156:159], v[136:139], v[36:39]
    ds_read_b128 v[132:135], v160 offset:7168
    v_mfma_f32_16x16x32_bf16 v[36:39], a[164:167], v[140:143], v[36:39]
L_hop2:
    s_cmp_eq_u32 s54, 1
    s_cbranch_scc1 L_hop3
    v_mfma_f32_16x16x32_bf16 v[40:43], a[144:147], v[136:139], v[40:43]
    s_add_u32 m0, s33, 10240
    s_add_u32 s36, s3, 0
    v_mfma_f32_16x16x32_bf16 v[40:43], a[152:155], v[140:143], v[40:43]
    s_waitcnt lgkmcnt(1)
    v_mfma_f32_16x16x32_bf16 v[40:43], a[160:163], v[128:131], v[40:43]
    v_mfma_f32_16x16x32_bf16 v[44:47], a[148:151], v[136:139], v[44:47]
    buffer_load_dwordx4 v163, s[24:27], s36 offen lds
    v_mfma_f32_16x16x32_bf16 v[44:47], a[156:159], v[140:143], v[44:47]
    s_waitcnt vmcnt(20)
    ds_read_b128 v[136:139], v160 offset:8192
    v_mfma_f32_16x16x32_bf16 v[44:47], a[164:167], v[128:131], v[44:47]
    ds_read_b64_tr_b16 a[176:177], v161 offset:12288
    v_mfma_f32_16x16x32_bf16 v[48:51], a[144:147], v[140:143], v[48:51]
    ds_read_b64_tr_b16 a[178:179], v161 offset:12544
    v_mfma_f32_16x16x32_bf16 v[48:51], a[152:155], v[128:131], v[48:51]
    s_waitcnt lgkmcnt(3)
    ds_read_b64_tr_b16 a[180:181], v161 offset:12296
    v_mfma_f32_16x16x32_bf16 v[48:51], a[160:163], v[132:135], v[48:51]
    ds_read_b64_tr_b16 a[182:183], v161 offset:12552
    v_mfma_f32_16x16x32_bf16 v[52:55], a[148:151], v[140:143], v[52:55]
    buffer_load_dwordx4 v164, s[24:27], s36 offen offset:1024 lds
    v_mfma_f32_16x16x32_bf16 v[52:55], a[156:159], v[128:131], v[52:55]
    s_waitcnt vmcnt(19)
    ds_read_b128 v[140:143], v160 offset:9216
    v_mfma_f32_16x16x32_bf16 v[52:55], a[164:167], v[132:135], v[52:55]
    ds_read_b64_tr_b16 a[184:185], v161 offset:14336
    v_mfma_f32_16x16x32_bf16 v[56:59], a[144:147], v[128:131], v[56:59]
    s_add_u32 m0, s34, 20480
    s_xor_b32 s37, s48, 768
    ds_read_b64_tr_b16 a[186:187], v161 offset:14592
    v_mfma_f32_16x16x32_bf16 v[56:59], a[152:155], v[132:135], v[56:59]
    s_waitcnt lgkmcnt(7)
    ds_read_b64_tr_b16 a[188:189], v161 offset:14344
    v_mfma_f32_16x16x32_bf16 v[56:59], a[160:163], v[136:139], v[56:59]
    ds_read_b64_tr_b16 a[190:191], v161 offset:14600
    v_mfma_f32_16x16x32_bf16 v[60:63], a[148:151], v[128:131], v[60:63]
    buffer_load_dwordx4 v162, s[20:23], s37 offen lds
    v_mfma_f32_16x16x32_bf16 v[60:63], a[156:159], v[132:135], v[60:63]
    s_waitcnt vmcnt(18)
    ds_read_b64_tr_b16 a[168:169], v161 offset:16384
    v_mfma_f32_16x16x32_bf16 v[60:63], a[164:167], v[136:139], v[60:63]
    ds_read_b64_tr_b16 a[170:171], v161 offset:16640
    v_mfma_f32_16x16x32_bf16 v[64:67], a[144:147], v[132:135], v[64:67]
    ds_read_b128 v[128:131], v160 offset:512
    v_mfma_f32_16x16x32_bf16 v[64:67], a[152:155], v[136:139], v[64:67]
    s_waitcnt lgkmcnt(7)
    ds_read_b64_tr_b16 a[172:173], v161 offset:16392
    v_mfma_f32_16x16x32_bf16 v[64:67], a[160:163], v[140:143], v[64:67]
    ds_read_b64_tr_b16 a[174:175], v161 offset:16648
    v_mfma_f32_16x16x32_bf16 v[68:71], a[148:151], v[132:135], v[68:71]
    buffer_load_dwordx4 v162, s[20:23], s37 offen offset:2048 lds
    v_mfma_f32_16x16x32_bf16 v[68:71], a[156:159], v[136:139], v[68:71]
    ds_read_b128 v[132:135], v160 offset:1536
    v_mfma_f32_16x16x32_bf16 v[68:71], a[164:167], v[140:143], v[68:71]
    v_mfma_f32_16x16x32_bf16 v[72:75], a[144:147], v[136:139], v[72:75]
    s_add_u32 m0, s34, 24576
    s_xor_b32 s37, s48, 4864
    v_mfma_f32_16x16x32_bf16 v[72:75], a[152:155], v[140:143], v[72:75]
    v_mfma_f32_16x16x32_bf16 v[76:79], a[148:151], v[136:139], v[76:79]
    ds_read_b128 v[136:139], v160 offset:2560
    v_mfma_f32_16x16x32_bf16 v[76:79], a[156:159], v[140:143], v[76:79]
    buffer_load_dwordx4 v162, s[20:23], s37 offen lds
    v_mfma_f32_16x16x32_bf16 v[80:83], a[144:147], v[140:143], v[80:83]
    v_mfma_f32_16x16x32_bf16 v[84:87], a[148:151], v[140:143], v[84:87]
    s_waitcnt lgkmcnt(2)
    v_mfma_f32_16x16x32_bf16 v[0:3], a[176:179], v[128:131], v[0:3]
    s_waitcnt lgkmcnt(1)
    ds_read_b128 v[140:143], v160 offset:3584
    v_mfma_f32_16x16x32_bf16 v[0:3], a[184:187], v[132:135], v[0:3]
    v_mfma_f32_16x16x32_bf16 v[4:7], a[180:183], v[128:131], v[4:7]
    v_mfma_f32_16x16x32_bf16 v[4:7], a[188:191], v[132:135], v[4:7]
    buffer_load_dwordx4 v162, s[20:23], s37 offen offset:2048 lds
    v_mfma_f32_16x16x32_bf16 v[8:11], a[168:171], v[128:131], v[8:11]
    v_mfma_f32_16x16x32_bf16 v[8:11], a[176:179], v[132:135], v[8:11]
    s_waitcnt lgkmcnt(1)
    v_mfma_f32_16x16x32_bf16 v[8:11], a[184:187], v[136:139], v[8:11]
    s_add_u32 m0, s34, 28672
    s_xor_b32 s37, s48, 8960
    v_mfma_f32_16x16x32_bf16 v[12:15], a[172:175], v[128:131], v[12:15]
    ds_read_b128 v[128:131], v160 offset:4608
    v_mfma_f32_16x16x32_bf16 v[12:15], a[180:183], v[132:135], v[12:15]
    v_mfma_f32_16x16x32_bf16 v[12:15], a[188:191], v[136:139], v[12:15]
    buffer_load_dwordx4 v162, s[20:23], s37 offen lds
    v_mfma_f32_16x16x32_bf16 v[16:19], a[168:171], v[132:135], v[16:19]
    v_mfma_f32_16x16x32_bf16 v[16:19], a[176:179], v[136:139], v[16:19]
    s_waitcnt lgkmcnt(1)
    v_mfma_f32_16x16x32_bf16 v[16:19], a[184:187], v[140:143], v[16:19]
    s_xor_b32 s3, s52, 393216
    s_add_u32 m0, s33, 12288
    s_add_u32 s36, s3, 524288
    v_mfma_f32_16x16x32_bf16 v[20:23], a[172:175], v[132:135], v[20:23]
    ds_read_b128 v[132:135], v160 offset:5632
    v_mfma_f32_16x16x32_bf16 v[20:23], a[180:183], v[136:139], v[20:23]
    v_mfma_f32_16x16x32_bf16 v[20:23], a[188:191], v[140:143], v[20:23]
    buffer_load_dwordx4 v163, s[24:27], s36 offen lds
    v_mfma_f32_16x16x32_bf16 v[24:27], a[168:171], v[136:139], v[24:27]
    v_mfma_f32_16x16x32_bf16 v[24:27], a[176:179], v[140:143], v[24:27]
    s_waitcnt lgkmcnt(1)
    v_mfma_f32_16x16x32_bf16 v[24:27], a[184:187], v[128:131], v[24:27]
    v_mfma_f32_16x16x32_bf16 v[28:31], a[172:175], v[136:139], v[28:31]
    ds_read_b128 v[136:139], v160 offset:6656
    v_mfma_f32_16x16x32_bf16 v[28:31], a[180:183], v[140:143], v[28:31]
    v_mfma_f32_16x16x32_bf16 v[28:31], a[188:191], v[128:131], v[28:31]
    buffer_load_dwordx4 v164, s[24:27], s36 offen offset:1024 lds
    v_mfma_f32_16x16x32_bf16 v[32:35], a[168:171], v[140:143], v[32:35]
    v_mfma_f32_16x16x32_bf16 v[32:35], a[176:179], v[128:131], v[32:35]
    s_waitcnt lgkmcnt(1)
    v_mfma_f32_16x16x32_bf16 v[32:35], a[184:187], v[132:135], v[32:35]
    s_add_u32 m0, s33, 14336
    s_add_u32 s36, s3, 1048576
    v_mfma_f32_16x16x32_bf16 v[36:39], a[172:175], v[140:143], v[36:39]
    ds_read_b128 v[140:143], v160 offset:7680
    v_mfma_f32_16x16x32_bf16 v[36:39], a[180:183], v[128:131], v[36:39]
    v_mfma_f32_16x16x32_bf16 v[36:39], a[188:191], v[132:135], v[36:39]
    buffer_load_dwordx4 v163, s[24:27], s36 offen lds
    v_mfma_f32_16x16x32_bf16 v[40:43], a[168:171], v[128:131], v[40:43]
    v_mfma_f32_16x16x32_bf16 v[40:43], a[176:179], v[132:135], v[40:43]
    s_waitcnt lgkmcnt(1)
    v_mfma_f32_16x16x32_bf16 v[40:43], a[184:187], v[136:139], v[40:43]
    v_mfma_f32_16x16x32_bf16 v[44:47], a[172:175], v[128:131], v[44:47]
    ds_read_b128 v[128:131], v160 offset:8704
    v_mfma_f32_16x16x32_bf16 v[44:47], a[180:183], v[132:135], v[44:47]
    s_waitcnt vmcnt(23)
    ds_read_b64_tr_b16 a[200:201], v161 offset:0
    v_mfma_f32_16x16x32_bf16 v[44:47], a[188:191], v[136:139], v[44:47]
    buffer_load_dwordx4 v164, s[24:27], s36 offen offset:1024 lds
    v_mfma_f32_16x16x32_bf16 v[48:51], a[168:171], v[132:135], v[48:51]
    ds_read_b64_tr_b16 a[202:203], v161 offset:256
    v_mfma_f32_16x16x32_bf16 v[48:51], a[176:179], v[136:139], v[48:51]
    s_waitcnt lgkmcnt(3)
    ds_read_b64_tr_b16 a[204:205], v161 offset:8
    v_mfma_f32_16x16x32_bf16 v[48:51], a[184:187], v[140:143], v[48:51]
    s_add_u32 m0, s33, 16384
    s_add_u32 s36, s3, 0
    ds_read_b64_tr_b16 a[206:207], v161 offset:264
    v_mfma_f32_16x16x32_bf16 v[52:55], a[172:175], v[132:135], v[52:55]
    ds_read_b128 v[132:135], v160 offset:9728
    v_mfma_f32_16x16x32_bf16 v[52:55], a[180:183], v[136:139], v[52:55]
    s_waitcnt vmcnt(22)
    ds_read_b64_tr_b16 a[208:209], v161 offset:2048
    v_mfma_f32_16x16x32_bf16 v[52:55], a[188:191], v[140:143], v[52:55]
    buffer_load_dwordx4 v163, s[24:27], s36 offen lds
    v_mfma_f32_16x16x32_bf16 v[56:59], a[168:171], v[136:139], v[56:59]
    ds_read_b64_tr_b16 a[210:211], v161 offset:2304
    v_mfma_f32_16x16x32_bf16 v[56:59], a[176:179], v[140:143], v[56:59]
    s_waitcnt lgkmcnt(7)
    ds_read_b64_tr_b16 a[212:213], v161 offset:2056
    v_mfma_f32_16x16x32_bf16 v[56:59], a[184:187], v[128:131], v[56:59]
    ds_read_b64_tr_b16 a[214:215], v161 offset:2312
    v_mfma_f32_16x16x32_bf16 v[60:63], a[172:175], v[136:139], v[60:63]
    v_mfma_f32_16x16x32_bf16 v[60:63], a[180:183], v[140:143], v[60:63]
    s_waitcnt vmcnt(21)
    ds_read_b64_tr_b16 a[192:193], v161 offset:4096
    v_mfma_f32_16x16x32_bf16 v[60:63], a[188:191], v[128:131], v[60:63]
    buffer_load_dwordx4 v164, s[24:27], s36 offen offset:1024 lds
    v_mfma_f32_16x16x32_bf16 v[64:67], a[168:171], v[140:143], v[64:67]
    ds_read_b64_tr_b16 a[194:195], v161 offset:4352
    v_mfma_f32_16x16x32_bf16 v[64:67], a[176:179], v[128:131], v[64:67]
    s_waitcnt lgkmcnt(6)
    ds_read_b64_tr_b16 a[196:197], v161 offset:4104
    v_mfma_f32_16x16x32_bf16 v[64:67], a[184:187], v[132:135], v[64:67]
    s_waitcnt vmcnt(17)
    s_barrier
    ds_read_b64_tr_b16 a[198:199], v161 offset:4360
    v_mfma_f32_16x16x32_bf16 v[68:71], a[172:175], v[140:143], v[68:71]
    s_xor_b32 s3, s52, 425984
    s_add_u32 m0, s33, 0
    ds_read_b128 v[136:139], v160 offset:10240
    v_mfma_f32_16x16x32_bf16 v[68:71], a[180:183], v[128:131], v[68:71]
    s_add_u32 s36, s3, 524288
    ds_read_b128 v[140:143], v160 offset:11264
    v_mfma_f32_16x16x32_bf16 v[68:71], a[188:191], v[132:135], v[68:71]
    buffer_load_dwordx4 v163, s[24:27], s36 offen lds
    v_mfma_f32_16x16x32_bf16 v[72:75], a[168:171], v[128:131], v[72:75]
    s_mov_b32 s47, 0x3ef5fdf0
    v_mfma_f32_16x16x32_bf16 v[72:75], a[176:179], v[132:135], v[72:75]
    v_lshlrev_b32_e32 v165, 16, v144
    v_lshlrev_b32_e32 v166, 16, v148
    v_mfma_f32_16x16x32_bf16 v[76:79], a[172:175], v[128:131], v[76:79]
    ds_read_b128 v[128:131], v160 offset:12288
    v_and_b32_e32 v144, 0xffff0000, v144
    v_mfma_f32_16x16x32_bf16 v[76:79], a[180:183], v[132:135], v[76:79]
    v_and_b32_e32 v148, 0xffff0000, v148
    v_mul_f32_e32 v144, s47, v144
    v_mfma_f32_16x16x32_bf16 v[80:83], a[168:171], v[132:135], v[80:83]
    v_mul_f32_e32 v165, s47, v165
    v_add_f32_e32 v144, 0x36a1369a, v144
    v_mfma_f32_16x16x32_bf16 v[84:87], a[172:175], v[132:135], v[84:87]
    s_waitcnt lgkmcnt(3)
    s_waitcnt lgkmcnt(2)
    v_mfma_f32_16x16x32_bf16 v[0:3], a[200:203], v[136:139], v[0:3]
    s_waitcnt lgkmcnt(1)
    ds_read_b128 v[132:135], v160 offset:13312
    v_add_f32_e32 v165, 0x36a1369a, v165
    v_mfma_f32_16x16x32_bf16 v[0:3], a[208:211], v[140:143], v[0:3]
    v_rsq_f32_e32 v144, v144
    v_mfma_f32_16x16x32_bf16 v[4:7], a[204:207], v[136:139], v[4:7]
    v_rsq_f32_e32 v165, v165
    v_mfma_f32_16x16x32_bf16 v[4:7], a[212:215], v[140:143], v[4:7]
    v_mul_f32_e32 v144, v144, v148
    v_mul_f32_e32 v148, v165, v166
    v_mfma_f32_16x16x32_bf16 v[8:11], a[192:195], v[136:139], v[8:11]
    v_lshlrev_b32_e32 v165, 16, v152
    v_lshlrev_b32_e32 v166, 16, v156
    v_mfma_f32_16x16x32_bf16 v[8:11], a[200:203], v[140:143], v[8:11]
    s_waitcnt lgkmcnt(1)
    buffer_load_dwordx4 v164, s[24:27], s36 offen offset:1024 lds
    v_mfma_f32_16x16x32_bf16 v[8:11], a[208:211], v[128:131], v[8:11]
    v_and_b32_e32 v152, 0xffff0000, v152
    v_and_b32_e32 v156, 0xffff0000, v156
    v_mfma_f32_16x16x32_bf16 v[12:15], a[196:199], v[136:139], v[12:15]
    ds_read_b128 v[136:139], v160 offset:14336
    v_mul_f32_e32 v156, s38, v156
    v_mfma_f32_16x16x32_bf16 v[12:15], a[204:207], v[140:143], v[12:15]
    s_add_u32 m0, s33, 2048
    v_mul_f32_e32 v166, s38, v166
    v_fma_f32 v156, -v152, v144, v156
    v_mfma_f32_16x16x32_bf16 v[12:15], a[212:215], v[128:131], v[12:15]
    s_add_u32 s36, s3, 1048576
    v_fma_f32 v152, -v165, v148, v166
    v_lshlrev_b32_e32 v165, 16, v145
    v_mfma_f32_16x16x32_bf16 v[16:19], a[192:195], v[140:143], v[16:19]
    v_lshlrev_b32_e32 v166, 16, v149
    v_and_b32_e32 v145, 0xffff0000, v145
    v_mfma_f32_16x16x32_bf16 v[16:19], a[200:203], v[128:131], v[16:19]
    s_waitcnt lgkmcnt(1)
    buffer_load_dwordx4 v163, s[24:27], s36 offen lds
    v_mfma_f32_16x16x32_bf16 v[16:19], a[208:211], v[132:135], v[16:19]
    v_and_b32_e32 v149, 0xffff0000, v149
    v_mul_f32_e32 v145, s47, v145
    v_mfma_f32_16x16x32_bf16 v[20:23], a[196:199], v[140:143], v[20:23]
    ds_read_b128 v[140:143], v160 offset:15360
    v_mul_f32_e32 v165, s47, v165
    v_mfma_f32_16x16x32_bf16 v[20:23], a[204:207], v[128:131], v[20:23]
    v_add_f32_e32 v145, 0x36a1369a, v145
    v_add_f32_e32 v165, 0x36a1369a, v165
    v_mfma_f32_16x16x32_bf16 v[20:23], a[212:215], v[132:135], v[20:23]
    v_rsq_f32_e32 v145, v145
    v_mfma_f32_16x16x32_bf16 v[24:27], a[192:195], v[128:131], v[24:27]
    v_rsq_f32_e32 v165, v165
    v_mfma_f32_16x16x32_bf16 v[24:27], a[200:203], v[132:135], v[24:27]
    s_waitcnt lgkmcnt(1)
    buffer_load_dwordx4 v164, s[24:27], s36 offen offset:1024 lds
    v_mfma_f32_16x16x32_bf16 v[24:27], a[208:211], v[136:139], v[24:27]
    v_mul_f32_e32 v145, v145, v149
    v_mul_f32_e32 v149, v165, v166
    v_mfma_f32_16x16x32_bf16 v[28:31], a[196:199], v[128:131], v[28:31]
    ds_read_b128 v[128:131], v160 offset:16384
    v_lshlrev_b32_e32 v165, 16, v153
    v_mfma_f32_16x16x32_bf16 v[28:31], a[204:207], v[132:135], v[28:31]
    s_add_u32 m0, s33, 4096
    v_lshlrev_b32_e32 v166, 16, v157
    v_and_b32_e32 v153, 0xffff0000, v153
    v_mfma_f32_16x16x32_bf16 v[28:31], a[212:215], v[136:139], v[28:31]
    s_add_u32 s36, s3, 0
    v_and_b32_e32 v157, 0xffff0000, v157
    v_mfma_f32_16x16x32_bf16 v[32:35], a[192:195], v[132:135], v[32:35]
    v_mul_f32_e32 v157, s38, v157
    v_mul_f32_e32 v166, s38, v166
    v_mfma_f32_16x16x32_bf16 v[32:35], a[200:203], v[136:139], v[32:35]
    s_waitcnt lgkmcnt(1)
    buffer_load_dwordx4 v163, s[24:27], s36 offen lds
    v_mfma_f32_16x16x32_bf16 v[32:35], a[208:211], v[140:143], v[32:35]
    v_fma_f32 v157, -v153, v145, v157
    v_fma_f32 v153, -v165, v149, v166
    v_mfma_f32_16x16x32_bf16 v[36:39], a[196:199], v[132:135], v[36:39]
    ds_read_b128 v[132:135], v160 offset:17408
    v_lshlrev_b32_e32 v165, 16, v146
    v_mfma_f32_16x16x32_bf16 v[36:39], a[204:207], v[136:139], v[36:39]
    v_lshlrev_b32_e32 v166, 16, v150
    v_and_b32_e32 v146, 0xffff0000, v146
    v_mfma_f32_16x16x32_bf16 v[36:39], a[212:215], v[140:143], v[36:39]
    v_and_b32_e32 v150, 0xffff0000, v150
    v_mul_f32_e32 v146, s47, v146
    v_mfma_f32_16x16x32_bf16 v[40:43], a[192:195], v[136:139], v[40:43]
    v_mul_f32_e32 v165, s47, v165
    v_add_f32_e32 v146, 0x36a1369a, v146
    v_mfma_f32_16x16x32_bf16 v[40:43], a[200:203], v[140:143], v[40:43]
    s_waitcnt lgkmcnt(1)
    buffer_load_dwordx4 v164, s[24:27], s36 offen offset:1024 lds
    v_mfma_f32_16x16x32_bf16 v[40:43], a[208:211], v[128:131], v[40:43]
    v_add_f32_e32 v165, 0x36a1369a, v165
    v_mfma_f32_16x16x32_bf16 v[44:47], a[196:199], v[136:139], v[44:47]
    ds_read_b128 v[136:139], v160 offset:18432
    v_mfma_f32_16x16x32_bf16 v[44:47], a[204:207], v[140:143], v[44:47]
    s_waitcnt vmcnt(21)
    s_add_u32 m0, s34, 30720
    ds_read_b64_tr_b16 a[224:225], v161 offset:6144
    v_mfma_f32_16x16x32_bf16 v[44:47], a[212:215], v[128:131], v[44:47]
    s_xor_b32 s37, s48, 896
    ds_read_b64_tr_b16 a[226:227], v161 offset:6400
    v_mfma_f32_16x16x32_bf16 v[48:51], a[192:195], v[140:143], v[48:51]
    ds_read_b64_tr_b16 a[228:229], v161 offset:6152
    v_mfma_f32_16x16x32_bf16 v[48:51], a[200:203], v[128:131], v[48:51]
    s_waitcnt lgkmcnt(4)
    buffer_load_dwordx4 v162, s[20:23], s37 offen lds
    v_mfma_f32_16x16x32_bf16 v[48:51], a[208:211], v[132:135], v[48:51]
    ds_read_b64_tr_b16 a[230:231], v161 offset:6408
    v_mfma_f32_16x16x32_bf16 v[52:55], a[196:199], v[140:143], v[52:55]
    ds_read_b128 v[140:143], v160 offset:19456
    v_mfma_f32_16x16x32_bf16 v[52:55], a[204:207], v[128:131], v[52:55]
    s_waitcnt vmcnt(20)
    ds_read_b64_tr_b16 a[232:233], v161 offset:8192
    v_mfma_f32_16x16x32_bf16 v[52:55], a[212:215], v[132:135], v[52:55]
    ds_read_b64_tr_b16 a[234:235], v161 offset:8448
    v_mfma_f32_16x16x32_bf16 v[56:59], a[192:195], v[128:131], v[56:59]
    ds_read_b64_tr_b16 a[236:237], v161 offset:8200
    v_mfma_f32_16x16x32_bf16 v[56:59], a[200:203], v[132:135], v[56:59]
    s_waitcnt lgkmcnt(8)
    buffer_load_dwordx4 v162, s[20:23], s37 offen offset:2048 lds
    v_mfma_f32_16x16x32_bf16 v[56:59], a[208:211], v[136:139], v[56:59]
    ds_read_b64_tr_b16 a[238:239], v161 offset:8456
    v_mfma_f32_16x16x32_bf16 v[60:63], a[196:199], v[128:131], v[60:63]
    v_rsq_f32_e32 v146, v146
    v_mfma_f32_16x16x32_bf16 v[60:63], a[204:207], v[132:135], v[60:63]
    s_waitcnt vmcnt(19)
    s_add_u32 m0, s34, 34816
    ds_read_b64_tr_b16 a[216:217], v161 offset:10240
    v_mfma_f32_16x16x32_bf16 v[60:63], a[212:215], v[136:139], v[60:63]
    s_xor_b32 s37, s48, 4992
    ds_read_b64_tr_b16 a[218:219], v161 offset:10496
    v_mfma_f32_16x16x32_bf16 v[64:67], a[192:195], v[132:135], v[64:67]
    ds_read_b128 v[128:131], v160 offset:10752
    v_mfma_f32_16x16x32_bf16 v[64:67], a[200:203], v[136:139], v[64:67]
    s_waitcnt lgkmcnt(7)
    buffer_load_dwordx4 v162, s[20:23], s37 offen lds
    v_mfma_f32_16x16x32_bf16 v[64:67], a[208:211], v[140:143], v[64:67]
    ds_read_b64_tr_b16 a[220:221], v161 offset:10248
    v_mfma_f32_16x16x32_bf16 v[68:71], a[196:199], v[132:135], v[68:71]
    ds_read_b128 v[132:135], v160 offset:11776
    v_mfma_f32_16x16x32_bf16 v[68:71], a[204:207], v[136:139], v[68:71]
    ds_read_b64_tr_b16 a[222:223], v161 offset:10504
    v_mfma_f32_16x16x32_bf16 v[68:71], a[212:215], v[140:143], v[68:71]
    v_rsq_f32_e32 v165, v165
    v_mfma_f32_16x16x32_bf16 v[72:75], a[192:195], v[136:139], v[72:75]
    v_mul_f32_e32 v146, v146, v150
    v_mul_f32_e32 v150, v165, v166
    v_mfma_f32_16x16x32_bf16 v[72:75], a[200:203], v[140:143], v[72:75]
    buffer_load_dwordx4 v162, s[20:23], s37 offen offset:2048 lds
    v_mfma_f32_16x16x32_bf16 v[76:79], a[196:199], v[136:139], v[76:79]
    ds_read_b128 v[136:139], v160 offset:12800
    v_lshlrev_b32_e32 v165, 16, v154
    v_mfma_f32_16x16x32_bf16 v[76:79], a[204:207], v[140:143], v[76:79]
    v_lshlrev_b32_e32 v166, 16, v158
    v_and_b32_e32 v154, 0xffff0000, v154
    v_mfma_f32_16x16x32_bf16 v[80:83], a[192:195], v[140:143], v[80:83]
    s_add_u32 m0, s34, 38912
    s_xor_b32 s37, s48, 9088
    v_and_b32_e32 v158, 0xffff0000, v158
    v_mfma_f32_16x16x32_bf16 v[84:87], a[196:199], v[140:143], v[84:87]
    s_waitcnt lgkmcnt(1)
    v_mul_f32_e32 v158, s38, v158
    v_mfma_f32_16x16x32_bf16 v[0:3], a[224:227], v[128:131], v[0:3]
    ds_read_b128 v[140:143], v160 offset:13824
    v_mul_f32_e32 v166, s38, v166
    v_mfma_f32_16x16x32_bf16 v[0:3], a[232:235], v[132:135], v[0:3]
    buffer_load_dwordx4 v162, s[20:23], s37 offen lds
    v_mfma_f32_16x16x32_bf16 v[4:7], a[228:231], v[128:131], v[4:7]
    v_fma_f32 v158, -v154, v146, v158
    v_fma_f32 v154, -v165, v150, v166
    v_mfma_f32_16x16x32_bf16 v[4:7], a[236:239], v[132:135], v[4:7]
    v_lshlrev_b32_e32 v165, 16, v147
    v_lshlrev_b32_e32 v166, 16, v151
    v_mfma_f32_16x16x32_bf16 v[8:11], a[216:219], v[128:131], v[8:11]
    s_xor_b32 s3, s52, 458752
    v_and_b32_e32 v147, 0xffff0000, v147
    v_and_b32_e32 v151, 0xffff0000, v151
    v_mfma_f32_16x16x32_bf16 v[8:11], a[224:227], v[132:135], v[8:11]
    s_waitcnt lgkmcnt(1)
    v_mul_f32_e32 v147, s47, v147
    v_mul_f32_e32 v165, s47, v165
    v_mfma_f32_16x16x32_bf16 v[8:11], a[232:235], v[136:139], v[8:11]
    s_add_u32 m0, s33, 6144
    v_add_f32_e32 v147, 0x36a1369a, v147
    v_add_f32_e32 v165, 0x36a1369a, v165
    v_mfma_f32_16x16x32_bf16 v[12:15], a[220:223], v[128:131], v[12:15]
    v_mfma_f32_16x16x32_bf16 v[12:15], a[228:231], v[132:135], v[12:15]
    s_add_u32 s36, s3, 524288
    ds_read_b128 v[128:131], v160 offset:14848
    v_mfma_f32_16x16x32_bf16 v[12:15], a[236:239], v[136:139], v[12:15]
    v_rsq_f32_e32 v147, v147
    v_mfma_f32_16x16x32_bf16 v[16:19], a[216:219], v[132:135], v[16:19]
    v_rsq_f32_e32 v165, v165
    v_mfma_f32_16x16x32_bf16 v[16:19], a[224:227], v[136:139], v[16:19]
    s_waitcnt lgkmcnt(1)
    v_mul_f32_e32 v147, v147, v151
    v_mul_f32_e32 v151, v165, v166
    v_mfma_f32_16x16x32_bf16 v[16:19], a[232:235], v[140:143], v[16:19]
    v_lshlrev_b32_e32 v165, 16, v155
    v_lshlrev_b32_e32 v166, 16, v159
    v_mfma_f32_16x16x32_bf16 v[20:23], a[220:223], v[132:135], v[20:23]
    buffer_load_dwordx4 v163, s[24:27], s36 offen lds
    v_mfma_f32_16x16x32_bf16 v[20:23], a[228:231], v[136:139], v[20:23]
    ds_read_b128 v[132:135], v160 offset:15872
    v_and_b32_e32 v155, 0xffff0000, v155
    v_mfma_f32_16x16x32_bf16 v[20:23], a[236:239], v[140:143], v[20:23]
    v_and_b32_e32 v159, 0xffff0000, v159
    v_mfma_f32_16x16x32_bf16 v[24:27], a[216:219], v[136:139], v[24:27]
    v_mul_f32_e32 v159, s38, v159
    v_mul_f32_e32 v166, s38, v166
    v_mfma_f32_16x16x32_bf16 v[24:27], a[224:227], v[140:143], v[24:27]
    s_waitcnt lgkmcnt(1)
    v_fma_f32 v159, -v155, v147, v159
    v_fma_f32 v155, -v165, v151, v166
    v_mfma_f32_16x16x32_bf16 v[24:27], a[232:235], v[128:131], v[24:27]
    v_mov_b32_e32 v165, s48
    v_mfma_f32_16x16x32_bf16 v[28:31], a[220:223], v[136:139], v[28:31]
    buffer_load_dwordx4 v164, s[24:27], s36 offen offset:1024 lds
    v_mfma_f32_16x16x32_bf16 v[28:31], a[228:231], v[140:143], v[28:31]
    ds_read_b128 v[136:139], v160 offset:16896
    v_mbcnt_lo_u32_b32 v166, -1, 0
    v_mfma_f32_16x16x32_bf16 v[28:31], a[236:239], v[128:131], v[28:31]
    v_mbcnt_hi_u32_b32 v166, -1, v166
    v_mfma_f32_16x16x32_bf16 v[32:35], a[216:219], v[140:143], v[32:35]
    s_add_u32 m0, s33, 8192
    s_add_u32 s36, s3, 1048576
    v_lshlrev_b32_e32 v166, 4, v166
    v_mfma_f32_16x16x32_bf16 v[32:35], a[224:227], v[128:131], v[32:35]
    s_waitcnt lgkmcnt(1)
    v_xor_b32_e32 v165, v165, v166
    v_mfma_f32_16x16x32_bf16 v[32:35], a[232:235], v[132:135], v[32:35]
    s_lshl_b32 s44, s32, 16
    v_mfma_f32_16x16x32_bf16 v[36:39], a[220:223], v[140:143], v[36:39]
    buffer_load_dwordx4 v163, s[24:27], s36 offen lds
    v_mfma_f32_16x16x32_bf16 v[36:39], a[228:231], v[128:131], v[36:39]
    s_add_u32 s44, s44, s51
    ds_read_b128 v[140:143], v160 offset:17920
    v_mfma_f32_16x16x32_bf16 v[36:39], a[236:239], v[132:135], v[36:39]
    v_add_u32_e32 v165, s44, v165
    v_mfma_f32_16x16x32_bf16 v[40:43], a[216:219], v[128:131], v[40:43]
    v_mov_b32_e32 v166, 0x1000000
    v_mfma_f32_16x16x32_bf16 v[40:43], a[224:227], v[132:135], v[40:43]
    s_waitcnt lgkmcnt(1)
    s_mov_b64 s[42:43], 0xff
    v_mfma_f32_16x16x32_bf16 v[40:43], a[232:235], v[136:139], v[40:43]
    v_cndmask_b32_e64 v165, v165, v166, s[42:43]
    v_mfma_f32_16x16x32_bf16 v[44:47], a[220:223], v[128:131], v[44:47]
    buffer_load_dwordx4 v164, s[24:27], s36 offen offset:1024 lds
    v_mfma_f32_16x16x32_bf16 v[44:47], a[228:231], v[132:135], v[44:47]
    s_waitcnt vmcnt(19)
    ds_read_b128 v[128:131], v160 offset:18944
    v_mfma_f32_16x16x32_bf16 v[44:47], a[236:239], v[136:139], v[44:47]
    ds_read_b64_tr_b16 a[248:249], v161 offset:12288
    v_mfma_f32_16x16x32_bf16 v[48:51], a[216:219], v[132:135], v[48:51]
    s_add_u32 m0, s33, 10240
    s_add_u32 s36, s3, 0
    ds_read_b64_tr_b16 a[250:251], v161 offset:12544
    v_mfma_f32_16x16x32_bf16 v[48:51], a[224:227], v[136:139], v[48:51]
    s_waitcnt lgkmcnt(3)
    ds_read_b64_tr_b16 a[252:253], v161 offset:12296
    v_mfma_f32_16x16x32_bf16 v[48:51], a[232:235], v[140:143], v[48:51]
    ds_read_b64_tr_b16 a[254:255], v161 offset:12552
    v_mfma_f32_16x16x32_bf16 v[52:55], a[220:223], v[132:135], v[52:55]
    buffer_load_dwordx4 v163, s[24:27], s36 offen lds
    v_mfma_f32_16x16x32_bf16 v[52:55], a[228:231], v[136:139], v[52:55]
    s_waitcnt vmcnt(18)
    ds_read_b128 v[132:135], v160 offset:19968
    v_mfma_f32_16x16x32_bf16 v[52:55], a[236:239], v[140:143], v[52:55]
    ds_read_b64_tr_b16 v[168:169], v161 offset:14336
    v_mfma_f32_16x16x32_bf16 v[56:59], a[216:219], v[136:139], v[56:59]
    ds_read_b64_tr_b16 v[170:171], v161 offset:14592
    v_mfma_f32_16x16x32_bf16 v[56:59], a[224:227], v[140:143], v[56:59]
    s_waitcnt lgkmcnt(7)
    ds_read_b64_tr_b16 v[172:173], v161 offset:14344
    v_mfma_f32_16x16x32_bf16 v[56:59], a[232:235], v[128:131], v[56:59]
    ds_read_b64_tr_b16 v[174:175], v161 offset:14600
    v_mfma_f32_16x16x32_bf16 v[60:63], a[220:223], v[136:139], v[60:63]
    buffer_load_dwordx4 v164, s[24:27], s36 offen offset:1024 lds
    v_mfma_f32_16x16x32_bf16 v[60:63], a[228:231], v[140:143], v[60:63]
    s_waitcnt vmcnt(17)
    ds_read_b64_tr_b16 a[240:241], v161 offset:16384
    v_mfma_f32_16x16x32_bf16 v[60:63], a[236:239], v[128:131], v[60:63]
    ds_read_b64_tr_b16 a[242:243], v161 offset:16640
    v_mfma_f32_16x16x32_bf16 v[64:67], a[216:219], v[140:143], v[64:67]
    s_xor_b32 s3, s52, 491520
    s_add_u32 m0, s33, 12288
    ds_read_b64_tr_b16 a[244:245], v161 offset:16392
    v_mfma_f32_16x16x32_bf16 v[64:67], a[224:227], v[128:131], v[64:67]
    s_waitcnt lgkmcnt(7)
    s_add_u32 s36, s3, 524288
    ds_read_b64_tr_b16 a[246:247], v161 offset:16648
    v_mfma_f32_16x16x32_bf16 v[64:67], a[232:235], v[132:135], v[64:67]
    s_barrier
    v_mfma_f32_16x16x32_bf16 v[68:71], a[220:223], v[140:143], v[68:71]
    buffer_load_dwordx4 v163, s[24:27], s36 offen lds
    v_mfma_f32_16x16x32_bf16 v[68:71], a[228:231], v[128:131], v[68:71]
    ds_read_b128 v[136:139], v160 offset:20480
    v_mfma_f32_16x16x32_bf16 v[68:71], a[236:239], v[132:135], v[68:71]
    ds_read_b128 v[140:143], v160 offset:21504
    v_mfma_f32_16x16x32_bf16 v[72:75], a[216:219], v[128:131], v[72:75]
    v_mfma_f32_16x16x32_bf16 v[72:75], a[224:227], v[132:135], v[72:75]
    v_mfma_f32_16x16x32_bf16 v[76:79], a[220:223], v[128:131], v[76:79]
    ds_read_b128 v[128:131], v160 offset:22528
    v_mfma_f32_16x16x32_bf16 v[76:79], a[228:231], v[132:135], v[76:79]
    buffer_load_dwordx4 v164, s[24:27], s36 offen offset:1024 lds
    v_mfma_f32_16x16x32_bf16 v[80:83], a[216:219], v[132:135], v[80:83]
    v_mfma_f32_16x16x32_bf16 v[84:87], a[220:223], v[132:135], v[84:87]
    s_waitcnt lgkmcnt(3)
    s_waitcnt lgkmcnt(2)
    v_mfma_f32_16x16x32_bf16 v[0:3], a[248:251], v[136:139], v[0:3]
    s_waitcnt lgkmcnt(1)
    s_add_u32 m0, s33, 14336
    ds_read_b128 v[132:135], v160 offset:23552
    v_mfma_f32_16x16x32_bf16 v[0:3], v[168:171], v[140:143], v[0:3]
    s_add_u32 s36, s3, 1048576
    v_mfma_f32_16x16x32_bf16 v[4:7], a[252:255], v[136:139], v[4:7]
    v_mfma_f32_16x16x32_bf16 v[4:7], v[172:175], v[140:143], v[4:7]
    buffer_load_dwordx4 v163, s[24:27], s36 offen lds
    v_mfma_f32_16x16x32_bf16 v[8:11], a[240:243], v[136:139], v[8:11]
    v_mfma_f32_16x16x32_bf16 v[8:11], a[248:251], v[140:143], v[8:11]
    s_waitcnt lgkmcnt(1)
    v_mfma_f32_16x16x32_bf16 v[8:11], v[168:171], v[128:131], v[8:11]
    v_mfma_f32_16x16x32_bf16 v[12:15], a[244:247], v[136:139], v[12:15]
    ds_read_b128 v[136:139], v160 offset:24576
    v_mfma_f32_16x16x32_bf16 v[12:15], a[252:255], v[140:143], v[12:15]
    v_mfma_f32_16x16x32_bf16 v[12:15], v[172:175], v[128:131], v[12:15]
    buffer_load_dwordx4 v164, s[24:27], s36 offen offset:1024 lds
    v_mfma_f32_16x16x32_bf16 v[16:19], a[240:243], v[140:143], v[16:19]
    v_mfma_f32_16x16x32_bf16 v[16:19], a[248:251], v[128:131], v[16:19]
    s_waitcnt lgkmcnt(1)
    v_mfma_f32_16x16x32_bf16 v[16:19], v[168:171], v[132:135], v[16:19]
    s_add_u32 m0, s33, 16384
    s_add_u32 s36, s3, 0
    v_mfma_f32_16x16x32_bf16 v[20:23], a[244:247], v[140:143], v[20:23]
    ds_read_b128 v[140:143], v160 offset:25600
    v_mfma_f32_16x16x32_bf16 v[20:23], a[252:255], v[128:131], v[20:23]
    v_mfma_f32_16x16x32_bf16 v[20:23], v[172:175], v[132:135], v[20:23]
    buffer_load_dwordx4 v163, s[24:27], s36 offen lds
    v_mfma_f32_16x16x32_bf16 v[24:27], a[240:243], v[128:131], v[24:27]
    v_mfma_f32_16x16x32_bf16 v[24:27], a[248:251], v[132:135], v[24:27]
    s_waitcnt lgkmcnt(1)
    v_mfma_f32_16x16x32_bf16 v[24:27], v[168:171], v[136:139], v[24:27]
    v_mfma_f32_16x16x32_bf16 v[28:31], a[244:247], v[128:131], v[28:31]
    ds_read_b128 v[128:131], v160 offset:26624
    v_mfma_f32_16x16x32_bf16 v[28:31], a[252:255], v[132:135], v[28:31]
    v_mfma_f32_16x16x32_bf16 v[28:31], v[172:175], v[136:139], v[28:31]
    buffer_load_dwordx4 v164, s[24:27], s36 offen offset:1024 lds
    v_mfma_f32_16x16x32_bf16 v[32:35], a[240:243], v[132:135], v[32:35]
    v_mbcnt_lo_u32_b32 v163, -1, 0
    v_mfma_f32_16x16x32_bf16 v[32:35], a[248:251], v[136:139], v[32:35]
    s_waitcnt lgkmcnt(1)
    v_mbcnt_hi_u32_b32 v163, -1, v163
    v_mfma_f32_16x16x32_bf16 v[32:35], v[168:171], v[140:143], v[32:35]
    s_add_u32 m0, s35, 0
    s_mov_b32 s37, 10240
    v_and_b32_e32 v162, 15, v163
    v_mfma_f32_16x16x32_bf16 v[36:39], a[244:247], v[132:135], v[36:39]
    ds_read_b128 v[132:135], v160 offset:27648
    v_lshlrev_b32_e32 v162, 14, v162
    v_mfma_f32_16x16x32_bf16 v[36:39], a[252:255], v[136:139], v[36:39]
    v_and_b32_e32 v166, 48, v163
    v_mfma_f32_16x16x32_bf16 v[36:39], v[172:175], v[140:143], v[36:39]
    buffer_load_dwordx4 v165, s[20:23], s37 offen lds
    v_mfma_f32_16x16x32_bf16 v[40:43], a[240:243], v[136:139], v[40:43]
    v_add3_u32 v162, v162, v166, s49
    v_mfma_f32_16x16x32_bf16 v[40:43], a[248:251], v[140:143], v[40:43]
    s_waitcnt lgkmcnt(1)
    v_bfe_u32 v164, v163, 3, 1
    v_mfma_f32_16x16x32_bf16 v[40:43], v[168:171], v[128:131], v[40:43]
    s_mov_b32 s37, 25568
    v_and_b32_e32 v163, 7, v163
    v_mfma_f32_16x16x32_bf16 v[44:47], a[244:247], v[136:139], v[44:47]
    ds_read_b128 v[136:139], v160 offset:28672
    v_mul_u32_u24_e32 v164, 40960, v164
    v_mfma_f32_16x16x32_bf16 v[44:47], a[252:255], v[140:143], v[44:47]
    s_waitcnt vmcnt(22)
    ds_read_b64_tr_b16 v[184:185], v161 offset:0
    v_mul_u32_u24_e32 v163, 1056, v163
    v_mfma_f32_16x16x32_bf16 v[44:47], v[172:175], v[128:131], v[44:47]
    buffer_load_dwordx4 v165, s[20:23], s37 offen offset:1056 lds
    v_mfma_f32_16x16x32_bf16 v[48:51], a[240:243], v[140:143], v[48:51]
    ds_read_b64_tr_b16 v[186:187], v161 offset:256
    v_add3_u32 v166, v166, v163, v164
    v_mfma_f32_16x16x32_bf16 v[48:51], a[248:251], v[128:131], v[48:51]
    s_waitcnt lgkmcnt(3)
    ds_read_b64_tr_b16 v[188:189], v161 offset:8
    v_mfma_f32_16x16x32_bf16 v[48:51], v[168:171], v[132:135], v[48:51]
L_hop3:
    s_cmp_eq_u32 s54, 1
    s_cbranch_scc1 L_back
    s_mov_b32 s37, 40896
    ds_read_b64_tr_b16 v[190:191], v161 offset:264
    v_mfma_f32_16x16x32_bf16 v[52:55], a[244:247], v[140:143], v[52:55]
    ds_read_b128 v[140:143], v160 offset:29696
    v_mfma_f32_16x16x32_bf16 v[52:55], a[252:255], v[128:131], v[52:55]
    s_waitcnt vmcnt(21)
    ds_read_b64_tr_b16 v[192:193], v161 offset:2048
    v_mfma_f32_16x16x32_bf16 v[52:55], v[172:175], v[132:135], v[52:55]
    buffer_load_dwordx4 v165, s[20:23], s37 offen offset:2112 lds
    v_mfma_f32_16x16x32_bf16 v[56:59], a[240:243], v[128:131], v[56:59]
    ds_read_b64_tr_b16 v[194:195], v161 offset:2304
    v_mfma_f32_16x16x32_bf16 v[56:59], a[248:251], v[132:135], v[56:59]
    s_waitcnt lgkmcnt(7)
    ds_read_b64_tr_b16 v[196:197], v161 offset:2056
    v_mfma_f32_16x16x32_bf16 v[56:59], v[168:171], v[136:139], v[56:59]
    s_mov_b32 s37, 56224
    ds_read_b64_tr_b16 v[198:199], v161 offset:2312
    v_mfma_f32_16x16x32_bf16 v[60:63], a[244:247], v[128:131], v[60:63]
    v_mfma_f32_16x16x32_bf16 v[60:63], a[252:255], v[132:135], v[60:63]
    s_waitcnt vmcnt(20)
    ds_read_b64_tr_b16 v[176:177], v161 offset:4096
    v_mfma_f32_16x16x32_bf16 v[60:63], v[172:175], v[136:139], v[60:63]
    buffer_load_dwordx4 v165, s[20:23], s37 offen offset:3168 lds
    v_mfma_f32_16x16x32_bf16 v[64:67], a[240:243], v[132:135], v[64:67]
    ds_read_b128 v[128:131], v160 offset:20992
    v_mfma_f32_16x16x32_bf16 v[64:67], a[248:251], v[136:139], v[64:67]
    s_waitcnt lgkmcnt(6)
    ds_read_b64_tr_b16 v[178:179], v161 offset:4352
    v_mfma_f32_16x16x32_bf16 v[64:67], v[168:171], v[140:143], v[64:67]
    ds_read_b64_tr_b16 v[180:181], v161 offset:4104
    v_mfma_f32_16x16x32_bf16 v[68:71], a[244:247], v[132:135], v[68:71]
    ds_read_b128 v[132:135], v160 offset:22016
    v_mfma_f32_16x16x32_bf16 v[68:71], a[252:255], v[136:139], v[68:71]
    ds_read_b64_tr_b16 v[182:183], v161 offset:4360
    v_mfma_f32_16x16x32_bf16 v[68:71], v[172:175], v[140:143], v[68:71]
    v_mfma_f32_16x16x32_bf16 v[72:75], a[240:243], v[136:139], v[72:75]
    v_mfma_f32_16x16x32_bf16 v[72:75], a[248:251], v[140:143], v[72:75]
    v_mfma_f32_16x16x32_bf16 v[76:79], a[244:247], v[136:139], v[76:79]
    ds_read_b128 v[136:139], v160 offset:23040
    v_mfma_f32_16x16x32_bf16 v[76:79], a[252:255], v[140:143], v[76:79]
    s_add_u32 m0, s33, 0
    s_mov_b32 s37, 12288
    v_mfma_f32_16x16x32_bf16 v[80:83], a[240:243], v[140:143], v[80:83]
    v_mfma_f32_16x16x32_bf16 v[84:87], a[244:247], v[140:143], v[84:87]
    s_waitcnt lgkmcnt(1)
    v_mfma_f32_16x16x32_bf16 v[0:3], v[184:187], v[128:131], v[0:3]
    ds_read_b128 v[140:143], v160 offset:24064
    v_mfma_f32_16x16x32_bf16 v[0:3], v[192:195], v[132:135], v[0:3]
    buffer_load_dwordx4 v165, s[20:23], s37 offen lds
    v_mfma_f32_16x16x32_bf16 v[4:7], v[188:191], v[128:131], v[4:7]
    v_mfma_f32_16x16x32_bf16 v[4:7], v[196:199], v[132:135], v[4:7]
    v_mfma_f32_16x16x32_bf16 v[8:11], v[176:179], v[128:131], v[8:11]
    s_mov_b32 s37, 27616
    v_mfma_f32_16x16x32_bf16 v[8:11], v[184:187], v[132:135], v[8:11]
    s_waitcnt lgkmcnt(1)
    v_mfma_f32_16x16x32_bf16 v[8:11], v[192:195], v[136:139], v[8:11]
    v_mfma_f32_16x16x32_bf16 v[12:15], v[180:183], v[128:131], v[12:15]
    ds_read_b128 v[128:131], v160 offset:25088
    v_mfma_f32_16x16x32_bf16 v[12:15], v[188:191], v[132:135], v[12:15]
    buffer_load_dwordx4 v165, s[20:23], s37 offen offset:1056 lds
    v_mfma_f32_16x16x32_bf16 v[12:15], v[196:199], v[136:139], v[12:15]
    v_mfma_f32_16x16x32_bf16 v[16:19], v[176:179], v[132:135], v[16:19]
    v_mfma_f32_16x16x32_bf16 v[16:19], v[184:187], v[136:139], v[16:19]
    s_waitcnt lgkmcnt(1)
    v_mfma_f32_16x16x32_bf16 v[16:19], v[192:195], v[140:143], v[16:19]
    s_mov_b32 s37, 42944
    v_mfma_f32_16x16x32_bf16 v[20:23], v[180:183], v[132:135], v[20:23]
    ds_read_b128 v[132:135], v160 offset:26112
    v_mfma_f32_16x16x32_bf16 v[20:23], v[188:191], v[136:139], v[20:23]
    buffer_load_dwordx4 v165, s[20:23], s37 offen offset:2112 lds
    v_mfma_f32_16x16x32_bf16 v[20:23], v[196:199], v[140:143], v[20:23]
    v_mfma_f32_16x16x32_bf16 v[24:27], v[176:179], v[136:139], v[24:27]
    v_mfma_f32_16x16x32_bf16 v[24:27], v[184:187], v[140:143], v[24:27]
    s_waitcnt lgkmcnt(1)
    v_mfma_f32_16x16x32_bf16 v[24:27], v[192:195], v[128:131], v[24:27]
    s_mov_b32 s37, 58272
    v_mfma_f32_16x16x32_bf16 v[28:31], v[180:183], v[136:139], v[28:31]
    ds_read_b128 v[136:139], v160 offset:27136
    v_mfma_f32_16x16x32_bf16 v[28:31], v[188:191], v[140:143], v[28:31]
    buffer_load_dwordx4 v165, s[20:23], s37 offen offset:3168 lds
    v_mfma_f32_16x16x32_bf16 v[28:31], v[196:199], v[128:131], v[28:31]
    v_mfma_f32_16x16x32_bf16 v[32:35], v[176:179], v[140:143], v[32:35]
    v_mfma_f32_16x16x32_bf16 v[32:35], v[184:187], v[128:131], v[32:35]
    s_waitcnt lgkmcnt(1)
    v_mfma_f32_16x16x32_bf16 v[32:35], v[192:195], v[132:135], v[32:35]
    v_mfma_f32_16x16x32_bf16 v[36:39], v[180:183], v[140:143], v[36:39]
    ds_read_b128 v[140:143], v160 offset:28160
    v_mfma_f32_16x16x32_bf16 v[36:39], v[188:191], v[128:131], v[36:39]
    v_mfma_f32_16x16x32_bf16 v[36:39], v[196:199], v[132:135], v[36:39]
    v_mfma_f32_16x16x32_bf16 v[40:43], v[176:179], v[128:131], v[40:43]
    v_mfma_f32_16x16x32_bf16 v[40:43], v[184:187], v[132:135], v[40:43]
    s_waitcnt lgkmcnt(1)
    v_mfma_f32_16x16x32_bf16 v[40:43], v[192:195], v[136:139], v[40:43]
    v_mfma_f32_16x16x32_bf16 v[44:47], v[180:183], v[128:131], v[44:47]
    ds_read_b128 v[128:131], v160 offset:29184
    v_mfma_f32_16x16x32_bf16 v[44:47], v[188:191], v[132:135], v[44:47]
    s_waitcnt vmcnt(18)
    ds_read_b64_tr_b16 v[208:209], v161 offset:6144
    v_mfma_f32_16x16x32_bf16 v[44:47], v[196:199], v[136:139], v[44:47]
    ds_read_b64_tr_b16 v[210:211], v161 offset:6400
    v_mfma_f32_16x16x32_bf16 v[48:51], v[176:179], v[132:135], v[48:51]
    ds_read_b64_tr_b16 v[212:213], v161 offset:6152
    v_mfma_f32_16x16x32_bf16 v[48:51], v[184:187], v[136:139], v[48:51]
    s_waitcnt lgkmcnt(4)
    v_mfma_f32_16x16x32_bf16 v[48:51], v[192:195], v[140:143], v[48:51]
    ds_read_b64_tr_b16 v[214:215], v161 offset:6408
    v_mfma_f32_16x16x32_bf16 v[52:55], v[180:183], v[132:135], v[52:55]
    ds_read_b128 v[132:135], v160 offset:30208
    v_mfma_f32_16x16x32_bf16 v[52:55], v[188:191], v[136:139], v[52:55]
    s_waitcnt vmcnt(16)
    ds_read_b64_tr_b16 v[216:217], v161 offset:8192
    v_mfma_f32_16x16x32_bf16 v[52:55], v[196:199], v[140:143], v[52:55]
    ds_read_b64_tr_b16 v[218:219], v161 offset:8448
    v_mfma_f32_16x16x32_bf16 v[56:59], v[176:179], v[136:139], v[56:59]
    ds_read_b64_tr_b16 v[220:221], v161 offset:8200
    v_mfma_f32_16x16x32_bf16 v[56:59], v[184:187], v[140:143], v[56:59]
    s_waitcnt lgkmcnt(8)
    v_mfma_f32_16x16x32_bf16 v[56:59], v[192:195], v[128:131], v[56:59]
    ds_read_b64_tr_b16 v[222:223], v161 offset:8456
    v_mfma_f32_16x16x32_bf16 v[60:63], v[180:183], v[136:139], v[60:63]
    v_mfma_f32_16x16x32_bf16 v[60:63], v[188:191], v[140:143], v[60:63]
    s_waitcnt vmcnt(14)
    ds_read_b64_tr_b16 v[200:201], v161 offset:10240
    v_mfma_f32_16x16x32_bf16 v[60:63], v[196:199], v[128:131], v[60:63]
    ds_read_b64_tr_b16 v[202:203], v161 offset:10496
    v_mfma_f32_16x16x32_bf16 v[64:67], v[176:179], v[140:143], v[64:67]
    s_add_u32 m0, s35, 10240
    s_mov_b32 s37, 11264
    ds_read_b64_tr_b16 v[204:205], v161 offset:10248
    v_mfma_f32_16x16x32_bf16 v[64:67], v[184:187], v[128:131], v[64:67]
    s_waitcnt lgkmcnt(7)
    v_mfma_f32_16x16x32_bf16 v[64:67], v[192:195], v[132:135], v[64:67]
    s_barrier
    ds_read_b64_tr_b16 v[206:207], v161 offset:10504
    v_mfma_f32_16x16x32_bf16 v[68:71], v[180:183], v[140:143], v[68:71]
    ds_read_b128 v[136:139], v160 offset:30720
    v_mfma_f32_16x16x32_bf16 v[68:71], v[188:191], v[128:131], v[68:71]
    ds_read_b128 v[140:143], v160 offset:31744
    v_mfma_f32_16x16x32_bf16 v[68:71], v[196:199], v[132:135], v[68:71]
    buffer_load_dwordx4 v165, s[20:23], s37 offen lds
    v_mfma_f32_16x16x32_bf16 v[72:75], v[176:179], v[128:131], v[72:75]
    v_mfma_f32_16x16x32_bf16 v[72:75], v[184:187], v[132:135], v[72:75]
    v_mfma_f32_16x16x32_bf16 v[76:79], v[180:183], v[128:131], v[76:79]
    s_mov_b32 s37, 26592
    ds_read_b128 v[128:131], v160 offset:32768
    v_mfma_f32_16x16x32_bf16 v[76:79], v[188:191], v[132:135], v[76:79]
    v_mfma_f32_16x16x32_bf16 v[80:83], v[176:179], v[132:135], v[80:83]
    v_mfma_f32_16x16x32_bf16 v[84:87], v[180:183], v[132:135], v[84:87]
    s_waitcnt lgkmcnt(3)
    s_waitcnt lgkmcnt(2)
    v_mfma_f32_16x16x32_bf16 v[0:3], v[208:211], v[136:139], v[0:3]
    s_waitcnt lgkmcnt(1)
    ds_read_b128 v[132:135], v160 offset:33792
    v_mfma_f32_16x16x32_bf16 v[0:3], v[216:219], v[140:143], v[0:3]
    buffer_load_dwordx4 v165, s[20:23], s37 offen offset:1056 lds
    v_mfma_f32_16x16x32_bf16 v[4:7], v[212:215], v[136:139], v[4:7]
    s_waitcnt vmcnt(14)
    ds_read_b64_tr_b16 v[232:233], v161 offset:12288
    v_mfma_f32_16x16x32_bf16 v[4:7], v[220:223], v[140:143], v[4:7]
    ds_read_b64_tr_b16 v[234:235], v161 offset:12544
    v_mfma_f32_16x16x32_bf16 v[8:11], v[200:203], v[136:139], v[8:11]
    s_mov_b32 s37, 41920
    ds_read_b64_tr_b16 v[236:237], v161 offset:12296
    v_mfma_f32_16x16x32_bf16 v[8:11], v[208:211], v[140:143], v[8:11]
    s_waitcnt lgkmcnt(4)
    ds_read_b64_tr_b16 v[238:239], v161 offset:12552
    v_mfma_f32_16x16x32_bf16 v[8:11], v[216:219], v[128:131], v[8:11]
    v_mfma_f32_16x16x32_bf16 v[12:15], v[204:207], v[136:139], v[12:15]
    buffer_load_dwordx4 v165, s[20:23], s37 offen offset:2112 lds
    v_mfma_f32_16x16x32_bf16 v[12:15], v[212:215], v[140:143], v[12:15]
    s_waitcnt vmcnt(13)
    ds_read_b128 v[136:139], v160 offset:34816
    v_mfma_f32_16x16x32_bf16 v[12:15], v[220:223], v[128:131], v[12:15]
    ds_read_b64_tr_b16 v[240:241], v161 offset:14336
    v_mfma_f32_16x16x32_bf16 v[16:19], v[200:203], v[140:143], v[16:19]
    s_mov_b32 s37, 57248
    ds_read_b64_tr_b16 v[242:243], v161 offset:14592
    v_mfma_f32_16x16x32_bf16 v[16:19], v[208:211], v[128:131], v[16:19]
    s_waitcnt lgkmcnt(7)
    ds_read_b64_tr_b16 v[244:245], v161 offset:14344
    v_mfma_f32_16x16x32_bf16 v[16:19], v[216:219], v[132:135], v[16:19]
    ds_read_b64_tr_b16 v[246:247], v161 offset:14600
    v_mfma_f32_16x16x32_bf16 v[20:23], v[204:207], v[140:143], v[20:23]
    buffer_load_dwordx4 v165, s[20:23], s37 offen offset:3168 lds
    v_mfma_f32_16x16x32_bf16 v[20:23], v[212:215], v[128:131], v[20:23]
    s_waitcnt vmcnt(12)
    ds_read_b64_tr_b16 v[224:225], v161 offset:16384
    v_mfma_f32_16x16x32_bf16 v[20:23], v[220:223], v[132:135], v[20:23]
    ds_read_b64_tr_b16 v[226:227], v161 offset:16640
    v_mfma_f32_16x16x32_bf16 v[24:27], v[200:203], v[128:131], v[24:27]
    s_add_u32 m0, s33, 4224
    s_mov_b32 s37, 13312
    ds_read_b128 v[140:143], v160 offset:31232
    v_mfma_f32_16x16x32_bf16 v[24:27], v[208:211], v[132:135], v[24:27]
    s_waitcnt lgkmcnt(7)
    ds_read_b64_tr_b16 v[228:229], v161 offset:16392
    v_mfma_f32_16x16x32_bf16 v[24:27], v[216:219], v[136:139], v[24:27]
    ds_read_b64_tr_b16 v[230:231], v161 offset:16648
    v_mfma_f32_16x16x32_bf16 v[28:31], v[204:207], v[128:131], v[28:31]
    buffer_load_dwordx4 v165, s[20:23], s37 offen lds
    v_mfma_f32_16x16x32_bf16 v[28:31], v[212:215], v[132:135], v[28:31]
    ds_read_b128 v[128:131], v160 offset:32256
    v_mfma_f32_16x16x32_bf16 v[28:31], v[220:223], v[136:139], v[28:31]
    v_mfma_f32_16x16x32_bf16 v[32:35], v[200:203], v[132:135], v[32:35]
    s_mov_b32 s37, 28640
    v_mfma_f32_16x16x32_bf16 v[32:35], v[208:211], v[136:139], v[32:35]
    v_mfma_f32_16x16x32_bf16 v[36:39], v[204:207], v[132:135], v[36:39]
    ds_read_b128 v[132:135], v160 offset:33280
    v_mfma_f32_16x16x32_bf16 v[36:39], v[212:215], v[136:139], v[36:39]
    buffer_load_dwordx4 v165, s[20:23], s37 offen offset:1056 lds
    v_mfma_f32_16x16x32_bf16 v[40:43], v[200:203], v[136:139], v[40:43]
    v_mfma_f32_16x16x32_bf16 v[44:47], v[204:207], v[136:139], v[44:47]
    s_waitcnt lgkmcnt(2)
    v_mfma_f32_16x16x32_bf16 v[0:3], v[232:235], v[140:143], v[0:3]
    s_waitcnt lgkmcnt(1)
    s_mov_b32 s37, 43968
    ds_read_b128 v[136:139], v160 offset:34304
    v_mfma_f32_16x16x32_bf16 v[0:3], v[240:243], v[128:131], v[0:3]
    v_mfma_f32_16x16x32_bf16 v[4:7], v[236:239], v[140:143], v[4:7]
    v_mfma_f32_16x16x32_bf16 v[4:7], v[244:247], v[128:131], v[4:7]
    buffer_load_dwordx4 v165, s[20:23], s37 offen offset:2112 lds
    v_mfma_f32_16x16x32_bf16 v[8:11], v[224:227], v[140:143], v[8:11]
    v_mfma_f32_16x16x32_bf16 v[8:11], v[232:235], v[128:131], v[8:11]
    s_waitcnt lgkmcnt(1)
    v_mfma_f32_16x16x32_bf16 v[8:11], v[240:243], v[132:135], v[8:11]
    s_mov_b32 s37, 59296
    v_mfma_f32_16x16x32_bf16 v[12:15], v[228:231], v[140:143], v[12:15]
    ds_read_b128 v[140:143], v160 offset:35328
    v_mfma_f32_16x16x32_bf16 v[12:15], v[236:239], v[128:131], v[12:15]
    v_mfma_f32_16x16x32_bf16 v[12:15], v[244:247], v[132:135], v[12:15]
    buffer_load_dwordx4 v165, s[20:23], s37 offen offset:3168 lds
    v_mfma_f32_16x16x32_bf16 v[16:19], v[224:227], v[128:131], v[16:19]
    v_fma_f32 v0, v0, v148, v152
    v_fma_f32 v1, v1, v144, v156
    v_mfma_f32_16x16x32_bf16 v[16:19], v[232:235], v[132:135], v[16:19]
    s_waitcnt lgkmcnt(1)
    v_exp_f32_e64 v163, -v0
    v_mfma_f32_16x16x32_bf16 v[16:19], v[240:243], v[136:139], v[16:19]
    s_add_u32 m0, s33, 8448
    s_mov_b32 s37, 14336
    v_fma_f32 v163, v163, s38, s38
    v_mfma_f32_16x16x32_bf16 v[20:23], v[228:231], v[128:131], v[20:23]
    v_rcp_f32_e32 v163, v163
    v_mfma_f32_16x16x32_bf16 v[20:23], v[236:239], v[132:135], v[20:23]
    v_exp_f32_e64 v164, -v1
    v_mfma_f32_16x16x32_bf16 v[20:23], v[244:247], v[136:139], v[20:23]
    buffer_load_dwordx4 v165, s[20:23], s37 offen lds
    v_mfma_f32_16x16x32_bf16 v[24:27], v[224:227], v[132:135], v[24:27]
    ds_read_b128 v[128:131], v160 offset:35840
    v_mul_f32_e32 v0, v0, v163
    v_mfma_f32_16x16x32_bf16 v[24:27], v[232:235], v[136:139], v[24:27]
    s_waitcnt lgkmcnt(1)
    v_fma_f32 v164, v164, s38, s38
    v_fma_f32 v2, v2, v149, v153
    v_mfma_f32_16x16x32_bf16 v[24:27], v[240:243], v[140:143], v[24:27]
    s_mov_b32 s37, 29664
    v_rcp_f32_e32 v164, v164
    v_mfma_f32_16x16x32_bf16 v[28:31], v[228:231], v[132:135], v[28:31]
    ds_read_b128 v[132:135], v160 offset:36864
    v_mul_f32_e32 v1, v1, v164
    v_mfma_f32_16x16x32_bf16 v[28:31], v[236:239], v[136:139], v[28:31]
    v_exp_f32_e64 v163, -v2
    v_mfma_f32_16x16x32_bf16 v[28:31], v[244:247], v[140:143], v[28:31]
    buffer_load_dwordx4 v165, s[20:23], s37 offen offset:1056 lds
    v_mfma_f32_16x16x32_bf16 v[32:35], v[224:227], v[136:139], v[32:35]
    v_fma_f32 v163, v163, s38, s38
    v_cvt_pk_bf16_f32 v0, v0, v1
    v_mfma_f32_16x16x32_bf16 v[32:35], v[232:235], v[140:143], v[32:35]
    v_rcp_f32_e32 v163, v163
    v_mfma_f32_16x16x32_bf16 v[36:39], v[228:231], v[136:139], v[36:39]
    s_mov_b32 s37, 44992
    ds_read_b128 v[136:139], v160 offset:37888
    v_mul_f32_e32 v2, v2, v163
    v_mfma_f32_16x16x32_bf16 v[36:39], v[236:239], v[140:143], v[36:39]
    v_fma_f32 v3, v3, v145, v157
    v_fma_f32 v4, v4, v150, v154
    v_mfma_f32_16x16x32_bf16 v[40:43], v[224:227], v[140:143], v[40:43]
    v_exp_f32_e64 v164, -v3
    v_mfma_f32_16x16x32_bf16 v[44:47], v[228:231], v[140:143], v[44:47]
    s_waitcnt lgkmcnt(2)
    buffer_load_dwordx4 v165, s[20:23], s37 offen offset:2112 lds
    v_mfma_f32_16x16x32_bf16 v[32:35], v[216:219], v[128:131], v[32:35]
    v_exp_f32_e64 v163, -v4
    v_mfma_f32_16x16x32_bf16 v[36:39], v[220:223], v[128:131], v[36:39]
    v_fma_f32 v164, v164, s38, s38
    v_fma_f32 v163, v163, s38, s38
    v_mfma_f32_16x16x32_bf16 v[40:43], v[208:211], v[128:131], v[40:43]
    s_waitcnt lgkmcnt(1)
    s_mov_b32 s37, 60320
    ds_read_b128 v[140:143], v160 offset:38912
    v_mfma_f32_16x16x32_bf16 v[40:43], v[216:219], v[132:135], v[40:43]
    v_rcp_f32_e32 v164, v164
    v_mfma_f32_16x16x32_bf16 v[44:47], v[212:215], v[128:131], v[44:47]
    v_rcp_f32_e32 v163, v163
    v_mfma_f32_16x16x32_bf16 v[44:47], v[220:223], v[132:135], v[44:47]
    buffer_load_dwordx4 v165, s[20:23], s37 offen offset:3168 lds
    v_mfma_f32_16x16x32_bf16 v[48:51], v[200:203], v[128:131], v[48:51]
    v_mul_f32_e32 v3, v3, v164
    v_mul_f32_e32 v4, v4, v163
    v_mfma_f32_16x16x32_bf16 v[48:51], v[208:211], v[132:135], v[48:51]
    s_waitcnt lgkmcnt(1)
    v_cvt_pk_bf16_f32 v1, v2, v3
    v_fma_f32 v5, v5, v146, v158
    v_mfma_f32_16x16x32_bf16 v[48:51], v[216:219], v[136:139], v[48:51]
    s_add_u32 m0, s33, 12672
    s_mov_b32 s37, 15360
    v_fma_f32 v6, v6, v151, v155
    v_mfma_f32_16x16x32_bf16 v[52:55], v[204:207], v[128:131], v[52:55]
    ds_read_b128 v[128:131], v160 offset:39936
    v_fma_f32 v7, v7, v147, v159
    v_mfma_f32_16x16x32_bf16 v[52:55], v[212:215], v[132:135], v[52:55]
    v_exp_f32_e64 v164, -v5
    v_mfma_f32_16x16x32_bf16 v[52:55], v[220:223], v[136:139], v[52:55]
    buffer_load_dwordx4 v165, s[20:23], s37 offen lds
    v_mfma_f32_16x16x32_bf16 v[56:59], v[200:203], v[132:135], v[56:59]
    v_exp_f32_e64 v163, -v6
    v_mfma_f32_16x16x32_bf16 v[56:59], v[208:211], v[136:139], v[56:59]
    s_waitcnt lgkmcnt(1)
    v_fma_f32 v164, v164, s38, s38
    v_fma_f32 v163, v163, s38, s38
    v_mfma_f32_16x16x32_bf16 v[56:59], v[216:219], v[140:143], v[56:59]
    s_mov_b32 s37, 30688
    v_rcp_f32_e32 v164, v164
    v_mfma_f32_16x16x32_bf16 v[60:63], v[204:207], v[132:135], v[60:63]
    v_rcp_f32_e32 v163, v163
    v_mfma_f32_16x16x32_bf16 v[60:63], v[212:215], v[136:139], v[60:63]
    v_mul_f32_e32 v5, v5, v164
    v_mul_f32_e32 v6, v6, v163
    v_mfma_f32_16x16x32_bf16 v[60:63], v[220:223], v[140:143], v[60:63]
    buffer_load_dwordx4 v165, s[20:23], s37 offen offset:1056 lds
    v_mfma_f32_16x16x32_bf16 v[64:67], v[200:203], v[136:139], v[64:67]
    ds_read_b128 v[132:135], v160 offset:36352
    v_cvt_pk_bf16_f32 v2, v4, v5
    v_mfma_f32_16x16x32_bf16 v[64:67], v[208:211], v[140:143], v[64:67]
    s_waitcnt lgkmcnt(1)
    v_exp_f32_e64 v164, -v7
    v_mfma_f32_16x16x32_bf16 v[64:67], v[216:219], v[128:131], v[64:67]
    s_mov_b32 s37, 46016
    v_fma_f32 v164, v164, s38, s38
    v_fma_f32 v8, v8, v148, v152
    v_mfma_f32_16x16x32_bf16 v[68:71], v[204:207], v[136:139], v[68:71]
    ds_read_b128 v[136:139], v160 offset:37376
    v_fma_f32 v9, v9, v144, v156
    v_mfma_f32_16x16x32_bf16 v[68:71], v[212:215], v[140:143], v[68:71]
    v_rcp_f32_e32 v164, v164
    v_mfma_f32_16x16x32_bf16 v[68:71], v[220:223], v[128:131], v[68:71]
    buffer_load_dwordx4 v165, s[20:23], s37 offen offset:2112 lds
    v_mfma_f32_16x16x32_bf16 v[72:75], v[200:203], v[140:143], v[72:75]
    v_exp_f32_e64 v163, -v8
    v_mfma_f32_16x16x32_bf16 v[72:75], v[208:211], v[128:131], v[72:75]
    v_mul_f32_e32 v7, v7, v164
    v_fma_f32 v163, v163, s38, s38
    v_mfma_f32_16x16x32_bf16 v[76:79], v[204:207], v[140:143], v[76:79]
    s_mov_b32 s37, 61344
    ds_read_b128 v[140:143], v160 offset:38400
    v_cvt_pk_bf16_f32 v3, v6, v7
    v_mfma_f32_16x16x32_bf16 v[76:79], v[212:215], v[128:131], v[76:79]
    v_rcp_f32_e32 v163, v163
    v_mfma_f32_16x16x32_bf16 v[80:83], v[200:203], v[128:131], v[80:83]
    v_exp_f32_e64 v164, -v9
    v_mfma_f32_16x16x32_bf16 v[84:87], v[204:207], v[128:131], v[84:87]
    s_waitcnt lgkmcnt(2)
    buffer_load_dwordx4 v165, s[20:23], s37 offen offset:3168 lds
    v_mfma_f32_16x16x32_bf16 v[32:35], v[240:243], v[132:135], v[32:35]
    v_mul_f32_e32 v8, v8, v163
    v_fma_f32 v164, v164, s38, s38
    v_mfma_f32_16x16x32_bf16 v[36:39], v[244:247], v[132:135], v[36:39]
    v_rcp_f32_e32 v164, v164
    v_mfma_f32_16x16x32_bf16 v[40:43], v[232:235], v[132:135], v[40:43]
    s_waitcnt lgkmcnt(1)
    ds_read_b128 v[128:131], v160 offset:39424
    v_mul_f32_e32 v9, v9, v164
    v_mfma_f32_16x16x32_bf16 v[40:43], v[240:243], v[136:139], v[40:43]
    v_cvt_pk_bf16_f32 v8, v8, v9
    v_fma_f32 v10, v10, v149, v153
    v_mfma_f32_16x16x32_bf16 v[44:47], v[236:239], v[132:135], v[44:47]
    v_exp_f32_e64 v4, -v10
    v_mfma_f32_16x16x32_bf16 v[44:47], v[244:247], v[136:139], v[44:47]
    v_fma_f32 v4, v4, s38, s38
    v_fma_f32 v11, v11, v145, v157
    v_mfma_f32_16x16x32_bf16 v[48:51], v[224:227], v[132:135], v[48:51]
    v_rcp_f32_e32 v4, v4
    v_mfma_f32_16x16x32_bf16 v[48:51], v[232:235], v[136:139], v[48:51]
    s_waitcnt lgkmcnt(1)
    v_exp_f32_e64 v5, -v11
    v_mfma_f32_16x16x32_bf16 v[48:51], v[240:243], v[140:143], v[48:51]
    v_mul_f32_e32 v10, v10, v4
    v_fma_f32 v5, v5, s38, s38
    v_mfma_f32_16x16x32_bf16 v[52:55], v[228:231], v[132:135], v[52:55]
    ds_read_b128 v[132:135], v160 offset:40448
    v_fma_f32 v12, v12, v150, v154
    v_mfma_f32_16x16x32_bf16 v[52:55], v[236:239], v[136:139], v[52:55]
    v_rcp_f32_e32 v5, v5
    v_mfma_f32_16x16x32_bf16 v[52:55], v[244:247], v[140:143], v[52:55]
    v_exp_f32_e64 v6, -v12
    v_mfma_f32_16x16x32_bf16 v[56:59], v[224:227], v[136:139], v[56:59]
    v_mul_f32_e32 v11, v11, v5
    v_fma_f32 v6, v6, s38, s38
    v_mfma_f32_16x16x32_bf16 v[56:59], v[232:235], v[140:143], v[56:59]
    s_waitcnt lgkmcnt(1)
    v_rcp_f32_e32 v6, v6
    v_mfma_f32_16x16x32_bf16 v[56:59], v[240:243], v[128:131], v[56:59]
    v_mul_f32_e32 v12, v12, v6
    v_cvt_pk_bf16_f32 v9, v10, v11
    v_mfma_f32_16x16x32_bf16 v[60:63], v[228:231], v[136:139], v[60:63]
    v_fma_f32 v13, v13, v146, v158
    v_fma_f32 v14, v14, v151, v155
    v_mfma_f32_16x16x32_bf16 v[60:63], v[236:239], v[140:143], v[60:63]
    v_exp_f32_e64 v7, -v13
    v_mfma_f32_16x16x32_bf16 v[60:63], v[244:247], v[128:131], v[60:63]
    v_exp_f32_e64 v163, -v14
    v_mfma_f32_16x16x32_bf16 v[64:67], v[224:227], v[140:143], v[64:67]
    v_fma_f32 v7, v7, s38, s38
    v_fma_f32 v163, v163, s38, s38
    v_mfma_f32_16x16x32_bf16 v[64:67], v[232:235], v[128:131], v[64:67]
    s_waitcnt lgkmcnt(0)
    v_rcp_f32_e32 v7, v7
    v_mfma_f32_16x16x32_bf16 v[64:67], v[240:243], v[132:135], v[64:67]
    s_waitcnt vmcnt(20)
    s_barrier
    v_mul_f32_e32 v13, v13, v7
    v_mfma_f32_16x16x32_bf16 v[68:71], v[228:231], v[140:143], v[68:71]
    ds_read_b128 v[136:139], v166 offset:128
    v_cvt_pk_bf16_f32 v10, v12, v13
    v_mfma_f32_16x16x32_bf16 v[68:71], v[236:239], v[128:131], v[68:71]
    ds_read_b128 v[140:143], v166 offset:192
    v_fma_f32 v15, v15, v147, v159
    v_mfma_f32_16x16x32_bf16 v[68:71], v[244:247], v[132:135], v[68:71]
    v_rcp_f32_e32 v163, v163
    v_mfma_f32_16x16x32_bf16 v[72:75], v[224:227], v[128:131], v[72:75]
    v_exp_f32_e64 v164, -v15
    v_mfma_f32_16x16x32_bf16 v[72:75], v[232:235], v[132:135], v[72:75]
    v_mul_f32_e32 v14, v14, v163
    v_fma_f32 v164, v164, s38, s38
    v_mfma_f32_16x16x32_bf16 v[76:79], v[228:231], v[128:131], v[76:79]
    v_rcp_f32_e32 v164, v164
    v_mfma_f32_16x16x32_bf16 v[76:79], v[236:239], v[132:135], v[76:79]
    v_mul_f32_e32 v15, v15, v164
    v_fma_f32 v16, v16, v148, v152
    v_mfma_f32_16x16x32_bf16 v[80:83], v[224:227], v[132:135], v[80:83]
    v_exp_f32_e64 v4, -v16
    v_mfma_f32_16x16x32_bf16 v[84:87], v[228:231], v[132:135], v[84:87]
    s_waitcnt lgkmcnt(0)
    v_cvt_pk_bf16_f32 v11, v14, v15
    v_fma_f32 v4, v4, s38, s38
    v_mfma_f32_16x16x32_bf16 v[72:75], a[16:19], v[136:139], v[72:75]
    ds_read_b128 v[128:131], v166 offset:256
    v_fma_f32 v17, v17, v144, v156
    v_mfma_f32_16x16x32_bf16 v[72:75], a[40:43], v[140:143], v[72:75]
    ds_read_b128 v[132:135], v166 offset:320
    v_fma_f32 v18, v18, v149, v153
    v_mfma_f32_16x16x32_bf16 v[76:79], a[20:23], v[136:139], v[76:79]
    v_rcp_f32_e32 v4, v4
    v_mfma_f32_16x16x32_bf16 v[76:79], a[44:47], v[140:143], v[76:79]
    v_exp_f32_e64 v5, -v17
    v_mfma_f32_16x16x32_bf16 v[80:83], a[8:11], v[136:139], v[80:83]
    v_exp_f32_e64 v6, -v18
    v_mfma_f32_16x16x32_bf16 v[80:83], a[32:35], v[140:143], v[80:83]
    v_mul_f32_e32 v16, v16, v4
    v_fma_f32 v5, v5, s38, s38
    v_mfma_f32_16x16x32_bf16 v[84:87], a[12:15], v[136:139], v[84:87]
    v_rcp_f32_e32 v5, v5
    v_mfma_f32_16x16x32_bf16 v[84:87], a[36:39], v[140:143], v[84:87]
    v_mul_f32_e32 v17, v17, v5
    v_fma_f32 v6, v6, s38, s38
    v_mfma_f32_16x16x32_bf16 v[88:91], a[0:3], v[136:139], v[88:91]
    v_rcp_f32_e32 v6, v6
    v_mfma_f32_16x16x32_bf16 v[88:91], a[24:27], v[140:143], v[88:91]
    v_mul_f32_e32 v18, v18, v6
    v_cvt_pk_bf16_f32 v16, v16, v17
    v_mfma_f32_16x16x32_bf16 v[92:95], a[4:7], v[136:139], v[92:95]
    v_fma_f32 v19, v19, v145, v157
    v_fma_f32 v20, v20, v150, v154
    v_mfma_f32_16x16x32_bf16 v[92:95], a[28:31], v[140:143], v[92:95]
    s_waitcnt lgkmcnt(0)
    v_exp_f32_e64 v7, -v19
    v_mfma_f32_16x16x32_bf16 v[72:75], a[64:67], v[128:131], v[72:75]
    ds_read_b128 v[136:139], v166 offset:384
    v_fma_f32 v7, v7, s38, s38
    v_mfma_f32_16x16x32_bf16 v[72:75], a[88:91], v[132:135], v[72:75]
    ds_read_b128 v[140:143], v166 offset:448
    v_fma_f32 v21, v21, v146, v158
    v_mfma_f32_16x16x32_bf16 v[76:79], a[68:71], v[128:131], v[76:79]
    v_rcp_f32_e32 v7, v7
    v_mfma_f32_16x16x32_bf16 v[76:79], a[92:95], v[132:135], v[76:79]
    v_exp_f32_e64 v163, -v20
    v_mfma_f32_16x16x32_bf16 v[80:83], a[56:59], v[128:131], v[80:83]
    v_exp_f32_e64 v164, -v21
    v_mfma_f32_16x16x32_bf16 v[80:83], a[80:83], v[132:135], v[80:83]
    v_mul_f32_e32 v19, v19, v7
    v_fma_f32 v163, v163, s38, s38
    v_mfma_f32_16x16x32_bf16 v[84:87], a[60:63], v[128:131], v[84:87]
    v_rcp_f32_e32 v163, v163
    v_mfma_f32_16x16x32_bf16 v[84:87], a[84:87], v[132:135], v[84:87]
    v_mul_f32_e32 v20, v20, v163
    v_fma_f32 v164, v164, s38, s38
    v_mfma_f32_16x16x32_bf16 v[88:91], a[48:51], v[128:131], v[88:91]
    v_rcp_f32_e32 v164, v164
    v_mfma_f32_16x16x32_bf16 v[88:91], a[72:75], v[132:135], v[88:91]
    v_mul_f32_e32 v21, v21, v164
    v_cvt_pk_bf16_f32 v17, v18, v19
    v_mfma_f32_16x16x32_bf16 v[92:95], a[52:55], v[128:131], v[92:95]
    v_cvt_pk_bf16_f32 v18, v20, v21
    v_fma_f32 v22, v22, v151, v155
    v_mfma_f32_16x16x32_bf16 v[92:95], a[76:79], v[132:135], v[92:95]
    s_waitcnt lgkmcnt(0)
    v_exp_f32_e64 v12, -v22
    v_mfma_f32_16x16x32_bf16 v[72:75], a[112:115], v[136:139], v[72:75]
    ds_read_b128 v[128:131], v166 offset:512
    v_fma_f32 v12, v12, s38, s38
    v_mfma_f32_16x16x32_bf16 v[72:75], a[136:139], v[140:143], v[72:75]
    ds_read_b128 v[132:135], v166 offset:576
    v_fma_f32 v23, v23, v147, v159
    v_mfma_f32_16x16x32_bf16 v[76:79], a[116:119], v[136:139], v[76:79]
    v_rcp_f32_e32 v12, v12
    v_mfma_f32_16x16x32_bf16 v[76:79], a[140:143], v[140:143], v[76:79]
    v_exp_f32_e64 v13, -v23
    v_mfma_f32_16x16x32_bf16 v[80:83], a[104:107], v[136:139], v[80:83]
    v_mul_f32_e32 v22, v22, v12
    v_fma_f32 v13, v13, s38, s38
    v_mfma_f32_16x16x32_bf16 v[80:83], a[128:131], v[140:143], v[80:83]
    v_rcp_f32_e32 v13, v13
    v_mfma_f32_16x16x32_bf16 v[84:87], a[108:111], v[136:139], v[84:87]
    v_mul_f32_e32 v23, v23, v13
    v_fma_f32 v24, v24, v148, v152
    v_mfma_f32_16x16x32_bf16 v[84:87], a[132:135], v[140:143], v[84:87]
    v_exp_f32_e64 v14, -v24
    v_mfma_f32_16x16x32_bf16 v[88:91], a[96:99], v[136:139], v[88:91]
    v_cvt_pk_bf16_f32 v19, v22, v23
    v_fma_f32 v14, v14, s38, s38
    v_mfma_f32_16x16x32_bf16 v[88:91], a[120:123], v[140:143], v[88:91]
    v_rcp_f32_e32 v14, v14
    v_mfma_f32_16x16x32_bf16 v[92:95], a[100:103], v[136:139], v[92:95]
    v_mul_f32_e32 v24, v24, v14
    v_fma_f32 v25, v25, v144, v156
    v_mfma_f32_16x16x32_bf16 v[92:95], a[124:127], v[140:143], v[92:95]
    s_waitcnt lgkmcnt(0)
    v_exp_f32_e64 v15, -v25
    v_mfma_f32_16x16x32_bf16 v[72:75], a[160:163], v[128:131], v[72:75]
    ds_read_b128 v[136:139], v166 offset:640
    v_fma_f32 v15, v15, s38, s38
    v_mfma_f32_16x16x32_bf16 v[72:75], a[184:187], v[132:135], v[72:75]
    ds_read_b128 v[140:143], v166 offset:704
    v_fma_f32 v26, v26, v149, v153
    v_mfma_f32_16x16x32_bf16 v[76:79], a[164:167], v[128:131], v[76:79]
    v_rcp_f32_e32 v15, v15
    v_mfma_f32_16x16x32_bf16 v[76:79], a[188:191], v[132:135], v[76:79]
    v_exp_f32_e64 v4, -v26
    v_mfma_f32_16x16x32_bf16 v[80:83], a[152:155], v[128:131], v[80:83]
    v_mul_f32_e32 v25, v25, v15
    v_fma_f32 v4, v4, s38, s38
    v_mfma_f32_16x16x32_bf16 v[80:83], a[176:179], v[132:135], v[80:83]
    v_rcp_f32_e32 v4, v4
    v_mfma_f32_16x16x32_bf16 v[84:87], a[156:159], v[128:131], v[84:87]
    v_mul_f32_e32 v26, v26, v4
    v_cvt_pk_bf16_f32 v24, v24, v25
    v_mfma_f32_16x16x32_bf16 v[84:87], a[180:183], v[132:135], v[84:87]
    v_fma_f32 v27, v27, v145, v157
    v_fma_f32 v28, v28, v150, v154
    v_mfma_f32_16x16x32_bf16 v[88:91], a[144:147], v[128:131], v[88:91]
    v_exp_f32_e64 v5, -v27
    v_mfma_f32_16x16x32_bf16 v[88:91], a[168:171], v[132:135], v[88:91]
L_hop4:
    s_cmp_eq_u32 s54, 1
    s_cbranch_scc1 L_hop5
    v_exp_f32_e64 v6, -v28
    v_mfma_f32_16x16x32_bf16 v[92:95], a[148:151], v[128:131], v[92:95]
    v_fma_f32 v5, v5, s38, s38
    v_fma_f32 v6, v6, s38, s38
    v_mfma_f32_16x16x32_bf16 v[92:95], a[172:175], v[132:135], v[92:95]
    s_waitcnt lgkmcnt(0)
    v_rcp_f32_e32 v5, v5
    v_mfma_f32_16x16x32_bf16 v[72:75], a[208:211], v[136:139], v[72:75]
    ds_read_b128 v[128:131], v166 offset:768
    v_mul_f32_e32 v27, v27, v5
    v_mfma_f32_16x16x32_bf16 v[72:75], a[232:235], v[140:143], v[72:75]
    ds_read_b128 v[132:135], v166 offset:832
    v_cvt_pk_bf16_f32 v25, v26, v27
    v_mfma_f32_16x16x32_bf16 v[76:79], a[212:215], v[136:139], v[76:79]
    v_rcp_f32_e32 v6, v6
    v_mfma_f32_16x16x32_bf16 v[76:79], a[236:239], v[140:143], v[76:79]
    v_mul_f32_e32 v28, v28, v6
    v_fma_f32 v29, v29, v146, v158
    v_mfma_f32_16x16x32_bf16 v[80:83], a[200:203], v[136:139], v[80:83]
    v_exp_f32_e64 v7, -v29
    v_mfma_f32_16x16x32_bf16 v[80:83], a[224:227], v[140:143], v[80:83]
    v_fma_f32 v7, v7, s38, s38
    v_fma_f32 v30, v30, v151, v155
    v_mfma_f32_16x16x32_bf16 v[84:87], a[204:207], v[136:139], v[84:87]
    v_rcp_f32_e32 v7, v7
    v_mfma_f32_16x16x32_bf16 v[84:87], a[228:231], v[140:143], v[84:87]
    v_exp_f32_e64 v163, -v30
    v_mfma_f32_16x16x32_bf16 v[88:91], a[192:195], v[136:139], v[88:91]
    v_mul_f32_e32 v29, v29, v7
    v_fma_f32 v163, v163, s38, s38
    v_mfma_f32_16x16x32_bf16 v[88:91], a[216:219], v[140:143], v[88:91]
    v_rcp_f32_e32 v163, v163
    v_mfma_f32_16x16x32_bf16 v[92:95], a[196:199], v[136:139], v[92:95]
    v_mul_f32_e32 v30, v30, v163
    v_cvt_pk_bf16_f32 v26, v28, v29
    v_mfma_f32_16x16x32_bf16 v[92:95], a[220:223], v[140:143], v[92:95]
    s_waitcnt lgkmcnt(0)
    v_fma_f32 v31, v31, v147, v159
    v_fma_f32 v32, v32, v148, v152
    v_mfma_f32_16x16x32_bf16 v[72:75], v[168:171], v[128:131], v[72:75]
    ds_read_b128 v[136:139], v166 offset:896
    v_fma_f32 v33, v33, v144, v156
    v_mfma_f32_16x16x32_bf16 v[72:75], v[192:195], v[132:135], v[72:75]
    ds_read_b128 v[140:143], v166 offset:960
    v_fma_f32 v34, v34, v149, v153
    v_mfma_f32_16x16x32_bf16 v[76:79], v[172:175], v[128:131], v[76:79]
    v_exp_f32_e64 v164, -v31
    v_mfma_f32_16x16x32_bf16 v[76:79], v[196:199], v[132:135], v[76:79]
    v_exp_f32_e64 v12, -v32
    v_mfma_f32_16x16x32_bf16 v[80:83], a[248:251], v[128:131], v[80:83]
    v_exp_f32_e64 v13, -v33
    v_mfma_f32_16x16x32_bf16 v[80:83], v[184:187], v[132:135], v[80:83]
    v_exp_f32_e64 v20, -v34
    v_mfma_f32_16x16x32_bf16 v[84:87], a[252:255], v[128:131], v[84:87]
    v_fma_f32 v164, v164, s38, s38
    v_fma_f32 v12, v12, s38, s38
    v_mfma_f32_16x16x32_bf16 v[84:87], v[188:191], v[132:135], v[84:87]
    v_rcp_f32_e32 v164, v164
    v_mfma_f32_16x16x32_bf16 v[88:91], a[240:243], v[128:131], v[88:91]
    v_rcp_f32_e32 v12, v12
    v_mfma_f32_16x16x32_bf16 v[88:91], v[176:179], v[132:135], v[88:91]
    v_mul_f32_e32 v31, v31, v164
    v_mul_f32_e32 v32, v32, v12
    v_mfma_f32_16x16x32_bf16 v[92:95], a[244:247], v[128:131], v[92:95]
    v_cvt_pk_bf16_f32 v27, v30, v31
    v_fma_f32 v13, v13, s38, s38
    v_mfma_f32_16x16x32_bf16 v[92:95], v[180:183], v[132:135], v[92:95]
    s_waitcnt lgkmcnt(0)
    v_rcp_f32_e32 v13, v13
    v_mfma_f32_16x16x32_bf16 v[72:75], v[216:219], v[136:139], v[72:75]
    v_mul_f32_e32 v33, v33, v13
    v_fma_f32 v20, v20, s38, s38
    v_mfma_f32_16x16x32_bf16 v[72:75], v[240:243], v[140:143], v[72:75]
    v_rcp_f32_e32 v20, v20
    v_mfma_f32_16x16x32_bf16 v[76:79], v[220:223], v[136:139], v[76:79]
    s_waitcnt vmcnt(12)
    s_barrier
    v_mul_f32_e32 v34, v34, v20
    v_mfma_f32_16x16x32_bf16 v[76:79], v[244:247], v[140:143], v[76:79]
    ds_read_b128 v[128:131], v166 offset:10368
    v_cvt_pk_bf16_f32 v32, v32, v33
    v_mfma_f32_16x16x32_bf16 v[80:83], v[208:211], v[136:139], v[80:83]
    ds_read_b128 v[132:135], v166 offset:10432
    v_fma_f32 v35, v35, v145, v157
    v_mfma_f32_16x16x32_bf16 v[80:83], v[232:235], v[140:143], v[80:83]
    v_exp_f32_e64 v21, -v35
    v_mfma_f32_16x16x32_bf16 v[84:87], v[212:215], v[136:139], v[84:87]
    v_fma_f32 v21, v21, s38, s38
    v_fma_f32 v36, v36, v150, v154
    v_mfma_f32_16x16x32_bf16 v[84:87], v[236:239], v[140:143], v[84:87]
    v_rcp_f32_e32 v21, v21
    v_mfma_f32_16x16x32_bf16 v[88:91], v[200:203], v[136:139], v[88:91]
    v_exp_f32_e64 v22, -v36
    v_mfma_f32_16x16x32_bf16 v[88:91], v[224:227], v[140:143], v[88:91]
    v_mul_f32_e32 v35, v35, v21
    v_fma_f32 v22, v22, s38, s38
    v_mfma_f32_16x16x32_bf16 v[92:95], v[204:207], v[136:139], v[92:95]
    v_rcp_f32_e32 v22, v22
    v_mfma_f32_16x16x32_bf16 v[92:95], v[228:231], v[140:143], v[92:95]
    s_waitcnt lgkmcnt(0)
    v_mul_f32_e32 v36, v36, v22
    v_cvt_pk_bf16_f32 v33, v34, v35
    v_mfma_f32_16x16x32_bf16 v[80:83], a[16:19], v[128:131], v[80:83]
    ds_read_b128 v[136:139], v166 offset:10496
    v_fma_f32 v37, v37, v146, v158
    v_mfma_f32_16x16x32_bf16 v[80:83], a[40:43], v[132:135], v[80:83]
    ds_read_b128 v[140:143], v166 offset:10560
    v_fma_f32 v38, v38, v151, v155
    v_mfma_f32_16x16x32_bf16 v[84:87], a[20:23], v[128:131], v[84:87]
    v_exp_f32_e64 v23, -v37
    v_mfma_f32_16x16x32_bf16 v[84:87], a[44:47], v[132:135], v[84:87]
    v_exp_f32_e64 v14, -v38
    v_mfma_f32_16x16x32_bf16 v[88:91], a[8:11], v[128:131], v[88:91]
    v_fma_f32 v23, v23, s38, s38
    v_fma_f32 v14, v14, s38, s38
    v_mfma_f32_16x16x32_bf16 v[88:91], a[32:35], v[132:135], v[88:91]
    v_rcp_f32_e32 v23, v23
    v_mfma_f32_16x16x32_bf16 v[92:95], a[12:15], v[128:131], v[92:95]
    v_rcp_f32_e32 v14, v14
    v_mfma_f32_16x16x32_bf16 v[92:95], a[36:39], v[132:135], v[92:95]
    v_mul_f32_e32 v37, v37, v23
    v_mul_f32_e32 v38, v38, v14
    v_mfma_f32_16x16x32_bf16 v[96:99], a[0:3], v[128:131], v[96:99]
    v_cvt_pk_bf16_f32 v34, v36, v37
    v_fma_f32 v39, v39, v147, v159
    v_mfma_f32_16x16x32_bf16 v[96:99], a[24:27], v[132:135], v[96:99]
    v_exp_f32_e64 v15, -v39
    v_mfma_f32_16x16x32_bf16 v[100:103], a[4:7], v[128:131], v[100:103]
    v_fma_f32 v15, v15, s38, s38
    v_fma_f32 v40, v40, v148, v152
    v_mfma_f32_16x16x32_bf16 v[100:103], a[28:31], v[132:135], v[100:103]
    s_waitcnt lgkmcnt(0)
    v_rcp_f32_e32 v15, v15
    v_mfma_f32_16x16x32_bf16 v[80:83], a[64:67], v[136:139], v[80:83]
    ds_read_b128 v[128:131], v166 offset:10624
    v_mul_f32_e32 v39, v39, v15
    v_mfma_f32_16x16x32_bf16 v[80:83], a[88:91], v[140:143], v[80:83]
    ds_read_b128 v[132:135], v166 offset:10688
    v_cvt_pk_bf16_f32 v35, v38, v39
    v_mfma_f32_16x16x32_bf16 v[84:87], a[68:71], v[136:139], v[84:87]
    v_exp_f32_e64 v4, -v40
    v_mfma_f32_16x16x32_bf16 v[84:87], a[92:95], v[140:143], v[84:87]
    v_fma_f32 v4, v4, s38, s38
    v_fma_f32 v41, v41, v144, v156
    v_mfma_f32_16x16x32_bf16 v[88:91], a[56:59], v[136:139], v[88:91]
    v_rcp_f32_e32 v4, v4
    v_mfma_f32_16x16x32_bf16 v[88:91], a[80:83], v[140:143], v[88:91]
    v_exp_f32_e64 v5, -v41
    v_mfma_f32_16x16x32_bf16 v[92:95], a[60:63], v[136:139], v[92:95]
    v_mul_f32_e32 v40, v40, v4
    v_fma_f32 v5, v5, s38, s38
    v_mfma_f32_16x16x32_bf16 v[92:95], a[84:87], v[140:143], v[92:95]
    v_rcp_f32_e32 v5, v5
    v_mfma_f32_16x16x32_bf16 v[96:99], a[48:51], v[136:139], v[96:99]
    v_mul_f32_e32 v41, v41, v5
    v_fma_f32 v42, v42, v149, v153
    v_mfma_f32_16x16x32_bf16 v[96:99], a[72:75], v[140:143], v[96:99]
    v_exp_f32_e64 v6, -v42
    v_mfma_f32_16x16x32_bf16 v[100:103], a[52:55], v[136:139], v[100:103]
    v_fma_f32 v6, v6, s38, s38
    v_cvt_pk_bf16_f32 v40, v40, v41
    v_mfma_f32_16x16x32_bf16 v[100:103], a[76:79], v[140:143], v[100:103]
    s_waitcnt lgkmcnt(0)
    v_rcp_f32_e32 v6, v6
    v_mfma_f32_16x16x32_bf16 v[80:83], a[112:115], v[128:131], v[80:83]
    ds_read_b128 v[136:139], v166 offset:10752
    v_mul_f32_e32 v42, v42, v6
    v_mfma_f32_16x16x32_bf16 v[80:83], a[136:139], v[132:135], v[80:83]
    ds_read_b128 v[140:143], v166 offset:10816
    v_fma_f32 v43, v43, v145, v157
    v_mfma_f32_16x16x32_bf16 v[84:87], a[116:119], v[128:131], v[84:87]
    v_exp_f32_e64 v7, -v43
    v_mfma_f32_16x16x32_bf16 v[84:87], a[140:143], v[132:135], v[84:87]
    v_fma_f32 v7, v7, s38, s38
    v_fma_f32 v44, v44, v150, v154
    v_mfma_f32_16x16x32_bf16 v[88:91], a[104:107], v[128:131], v[88:91]
    v_rcp_f32_e32 v7, v7
    v_mfma_f32_16x16x32_bf16 v[88:91], a[128:131], v[132:135], v[88:91]
    v_exp_f32_e64 v163, -v44
    v_mfma_f32_16x16x32_bf16 v[92:95], a[108:111], v[128:131], v[92:95]
    v_mul_f32_e32 v43, v43, v7
    v_fma_f32 v163, v163, s38, s38
    v_mfma_f32_16x16x32_bf16 v[92:95], a[132:135], v[132:135], v[92:95]
    v_rcp_f32_e32 v163, v163
    v_mfma_f32_16x16x32_bf16 v[96:99], a[96:99], v[128:131], v[96:99]
    v_mul_f32_e32 v44, v44, v163
    v_cvt_pk_bf16_f32 v41, v42, v43
    v_mfma_f32_16x16x32_bf16 v[96:99], a[120:123], v[132:135], v[96:99]
    v_fma_f32 v45, v45, v146, v158
    v_fma_f32 v46, v46, v151, v155
    v_mfma_f32_16x16x32_bf16 v[100:103], a[100:103], v[128:131], v[100:103]
    v_exp_f32_e64 v164, -v45
    v_mfma_f32_16x16x32_bf16 v[100:103], a[124:127], v[132:135], v[100:103]
    s_waitcnt lgkmcnt(0)
    v_exp_f32_e64 v12, -v46
    v_mfma_f32_16x16x32_bf16 v[80:83], a[160:163], v[136:139], v[80:83]
    ds_read_b128 v[128:131], v166 offset:10880
    v_fma_f32 v164, v164, s38, s38
    v_mfma_f32_16x16x32_bf16 v[80:83], a[184:187], v[140:143], v[80:83]
    ds_read_b128 v[132:135], v166 offset:10944
    v_fma_f32 v12, v12, s38, s38
    v_mfma_f32_16x16x32_bf16 v[84:87], a[164:167], v[136:139], v[84:87]
    v_rcp_f32_e32 v164, v164
    v_mfma_f32_16x16x32_bf16 v[84:87], a[188:191], v[140:143], v[84:87]
    v_rcp_f32_e32 v12, v12
    v_mfma_f32_16x16x32_bf16 v[88:91], a[152:155], v[136:139], v[88:91]
    v_mul_f32_e32 v45, v45, v164
    v_mul_f32_e32 v46, v46, v12
    v_mfma_f32_16x16x32_bf16 v[88:91], a[176:179], v[140:143], v[88:91]
    v_cvt_pk_bf16_f32 v42, v44, v45
    v_fma_f32 v47, v47, v147, v159
    v_mfma_f32_16x16x32_bf16 v[92:95], a[156:159], v[136:139], v[92:95]
    v_exp_f32_e64 v28, -v47
    v_mfma_f32_16x16x32_bf16 v[92:95], a[180:183], v[140:143], v[92:95]
    v_fma_f32 v28, v28, s38, s38
    v_fma_f32 v48, v48, v148, v152
    v_mfma_f32_16x16x32_bf16 v[96:99], a[144:147], v[136:139], v[96:99]
    v_rcp_f32_e32 v28, v28
    v_mfma_f32_16x16x32_bf16 v[96:99], a[168:171], v[140:143], v[96:99]
    v_exp_f32_e64 v29, -v48
    v_mfma_f32_16x16x32_bf16 v[100:103], a[148:151], v[136:139], v[100:103]
    v_mul_f32_e32 v47, v47, v28
    v_fma_f32 v29, v29, s38, s38
    v_mfma_f32_16x16x32_bf16 v[100:103], a[172:175], v[140:143], v[100:103]
    s_waitcnt lgkmcnt(0)
    v_rcp_f32_e32 v29, v29
    v_mfma_f32_16x16x32_bf16 v[80:83], a[208:211], v[128:131], v[80:83]
    ds_read_b128 v[136:139], v166 offset:11008
    v_cvt_pk_bf16_f32 v43, v46, v47
    v_mfma_f32_16x16x32_bf16 v[80:83], a[232:235], v[132:135], v[80:83]
    ds_read_b128 v[140:143], v166 offset:11072
    v_mul_f32_e32 v48, v48, v29
    v_mfma_f32_16x16x32_bf16 v[84:87], a[212:215], v[128:131], v[84:87]
    v_fma_f32 v49, v49, v144, v156
    v_fma_f32 v50, v50, v149, v153
    v_mfma_f32_16x16x32_bf16 v[84:87], a[236:239], v[132:135], v[84:87]
    v_exp_f32_e64 v30, -v49
    v_mfma_f32_16x16x32_bf16 v[88:91], a[200:203], v[128:131], v[88:91]
    v_exp_f32_e64 v31, -v50
    v_mfma_f32_16x16x32_bf16 v[88:91], a[224:227], v[132:135], v[88:91]
    v_fma_f32 v30, v30, s38, s38
    v_fma_f32 v31, v31, s38, s38
    v_mfma_f32_16x16x32_bf16 v[92:95], a[204:207], v[128:131], v[92:95]
    v_rcp_f32_e32 v30, v30
    v_mfma_f32_16x16x32_bf16 v[92:95], a[228:231], v[132:135], v[92:95]
    v_rcp_f32_e32 v31, v31
    v_mfma_f32_16x16x32_bf16 v[96:99], a[192:195], v[128:131], v[96:99]
    v_mul_f32_e32 v49, v49, v30
    v_mul_f32_e32 v50, v50, v31
    v_mfma_f32_16x16x32_bf16 v[96:99], a[216:219], v[132:135], v[96:99]
    v_cvt_pk_bf16_f32 v48, v48, v49
    v_fma_f32 v51, v51, v145, v157
    v_mfma_f32_16x16x32_bf16 v[100:103], a[196:199], v[128:131], v[100:103]
    v_exp_f32_e64 v13, -v51
    v_mfma_f32_16x16x32_bf16 v[100:103], a[220:223], v[132:135], v[100:103]
    s_waitcnt lgkmcnt(0)
    v_fma_f32 v13, v13, s38, s38
    v_fma_f32 v52, v52, v150, v154
    v_mfma_f32_16x16x32_bf16 v[80:83], v[168:171], v[136:139], v[80:83]
    ds_read_b128 v[128:131], v166 offset:11136
    v_fma_f32 v53, v53, v146, v158
    v_mfma_f32_16x16x32_bf16 v[80:83], v[192:195], v[140:143], v[80:83]
    ds_read_b128 v[132:135], v166 offset:11200
    v_fma_f32 v54, v54, v151, v155
    v_mfma_f32_16x16x32_bf16 v[84:87], v[172:175], v[136:139], v[84:87]
    v_rcp_f32_e32 v13, v13
    v_mfma_f32_16x16x32_bf16 v[84:87], v[196:199], v[140:143], v[84:87]
    v_exp_f32_e64 v20, -v52
    v_mfma_f32_16x16x32_bf16 v[88:91], a[248:251], v[136:139], v[88:91]
    v_exp_f32_e64 v21, -v53
    v_mfma_f32_16x16x32_bf16 v[88:91], v[184:187], v[140:143], v[88:91]
    v_exp_f32_e64 v22, -v54
    v_mfma_f32_16x16x32_bf16 v[92:95], a[252:255], v[136:139], v[92:95]
    v_mul_f32_e32 v51, v51, v13
    v_fma_f32 v20, v20, s38, s38
    v_mfma_f32_16x16x32_bf16 v[92:95], v[188:191], v[140:143], v[92:95]
    v_rcp_f32_e32 v20, v20
    v_mfma_f32_16x16x32_bf16 v[96:99], a[240:243], v[136:139], v[96:99]
    v_mul_f32_e32 v52, v52, v20
    v_fma_f32 v21, v21, s38, s38
    v_mfma_f32_16x16x32_bf16 v[96:99], v[176:179], v[140:143], v[96:99]
    v_rcp_f32_e32 v21, v21
    v_mfma_f32_16x16x32_bf16 v[100:103], a[244:247], v[136:139], v[100:103]
    v_mul_f32_e32 v53, v53, v21
    v_fma_f32 v22, v22, s38, s38
    v_mfma_f32_16x16x32_bf16 v[100:103], v[180:183], v[140:143], v[100:103]
    s_waitcnt lgkmcnt(0)
    v_rcp_f32_e32 v22, v22
    v_mfma_f32_16x16x32_bf16 v[80:83], v[216:219], v[128:131], v[80:83]
    v_mul_f32_e32 v54, v54, v22
    v_cvt_pk_bf16_f32 v49, v50, v51
    v_mfma_f32_16x16x32_bf16 v[80:83], v[240:243], v[132:135], v[80:83]
    v_cvt_pk_bf16_f32 v50, v52, v53
    v_fma_f32 v55, v55, v147, v159
    v_mfma_f32_16x16x32_bf16 v[84:87], v[220:223], v[128:131], v[84:87]
    s_waitcnt vmcnt(0)
    s_barrier
    v_fma_f32 v56, v56, v148, v152
    v_mfma_f32_16x16x32_bf16 v[84:87], v[244:247], v[132:135], v[84:87]
    ds_read_b128 v[136:139], v167 offset:128
    v_fma_f32 v57, v57, v144, v156
    v_mfma_f32_16x16x32_bf16 v[88:91], v[208:211], v[128:131], v[88:91]
    ds_read_b128 v[140:143], v167 offset:192
    v_fma_f32 v58, v58, v149, v153
    v_mfma_f32_16x16x32_bf16 v[88:91], v[232:235], v[132:135], v[88:91]
    buffer_store_dwordx4 v[0:3], v162, s[28:31], 0 offen sc0 sc1
    v_mfma_f32_16x16x32_bf16 v[92:95], v[212:215], v[128:131], v[92:95]
    v_exp_f32_e64 v23, -v55
    v_mfma_f32_16x16x32_bf16 v[92:95], v[236:239], v[132:135], v[92:95]
    v_exp_f32_e64 v14, -v56
    v_mfma_f32_16x16x32_bf16 v[96:99], v[200:203], v[128:131], v[96:99]
    v_exp_f32_e64 v15, -v57
    v_mfma_f32_16x16x32_bf16 v[96:99], v[224:227], v[132:135], v[96:99]
    v_exp_f32_e64 v36, -v58
    v_mfma_f32_16x16x32_bf16 v[100:103], v[204:207], v[128:131], v[100:103]
    v_fma_f32 v23, v23, s38, s38
    v_fma_f32 v14, v14, s38, s38
    v_mfma_f32_16x16x32_bf16 v[100:103], v[228:231], v[132:135], v[100:103]
    s_waitcnt lgkmcnt(0)
    v_rcp_f32_e32 v23, v23
    v_mfma_f32_16x16x32_bf16 v[88:91], a[16:19], v[136:139], v[88:91]
    ds_read_b128 v[128:131], v167 offset:256
    v_mul_f32_e32 v55, v55, v23
    v_mfma_f32_16x16x32_bf16 v[88:91], a[40:43], v[140:143], v[88:91]
    ds_read_b128 v[132:135], v167 offset:320
    v_cvt_pk_bf16_f32 v51, v54, v55
    v_mfma_f32_16x16x32_bf16 v[92:95], a[20:23], v[136:139], v[92:95]
    v_rcp_f32_e32 v14, v14
    v_mfma_f32_16x16x32_bf16 v[92:95], a[44:47], v[140:143], v[92:95]
    v_mul_f32_e32 v56, v56, v14
    v_fma_f32 v15, v15, s38, s38
    v_mfma_f32_16x16x32_bf16 v[96:99], a[8:11], v[136:139], v[96:99]
    v_rcp_f32_e32 v15, v15
    v_mfma_f32_16x16x32_bf16 v[96:99], a[32:35], v[140:143], v[96:99]
    v_mul_f32_e32 v57, v57, v15
    v_fma_f32 v36, v36, s38, s38
    v_mfma_f32_16x16x32_bf16 v[100:103], a[12:15], v[136:139], v[100:103]
    v_rcp_f32_e32 v36, v36
    v_mfma_f32_16x16x32_bf16 v[100:103], a[36:39], v[140:143], v[100:103]
    v_mul_f32_e32 v58, v58, v36
    v_cvt_pk_bf16_f32 v56, v56, v57
    v_mfma_f32_16x16x32_bf16 v[104:107], a[0:3], v[136:139], v[104:107]
    v_fma_f32 v59, v59, v145, v157
    v_fma_f32 v60, v60, v150, v154
    v_mfma_f32_16x16x32_bf16 v[104:107], a[24:27], v[140:143], v[104:107]
    v_exp_f32_e64 v37, -v59
    v_mfma_f32_16x16x32_bf16 v[108:111], a[4:7], v[136:139], v[108:111]
    v_exp_f32_e64 v38, -v60
    v_mfma_f32_16x16x32_bf16 v[108:111], a[28:31], v[140:143], v[108:111]
    s_waitcnt lgkmcnt(0)
    v_fma_f32 v37, v37, s38, s38
    v_fma_f32 v38, v38, s38, s38
    v_mfma_f32_16x16x32_bf16 v[88:91], a[64:67], v[128:131], v[88:91]
    ds_read_b128 v[136:139], v167 offset:384
    v_fma_f32 v61, v61, v146, v158
    v_mfma_f32_16x16x32_bf16 v[88:91], a[88:91], v[132:135], v[88:91]
    ds_read_b128 v[140:143], v167 offset:448
    v_fma_f32 v62, v62, v151, v155
    v_mfma_f32_16x16x32_bf16 v[92:95], a[68:71], v[128:131], v[92:95]
    buffer_store_dwordx4 v[8:11], v162, s[28:31], 0 offen offset:1024 sc0 sc1
    v_mfma_f32_16x16x32_bf16 v[92:95], a[92:95], v[132:135], v[92:95]
    v_rcp_f32_e32 v37, v37
    v_mfma_f32_16x16x32_bf16 v[96:99], a[56:59], v[128:131], v[96:99]
    v_rcp_f32_e32 v38, v38
    v_mfma_f32_16x16x32_bf16 v[96:99], a[80:83], v[132:135], v[96:99]
    v_exp_f32_e64 v39, -v61
    v_mfma_f32_16x16x32_bf16 v[100:103], a[60:63], v[128:131], v[100:103]
    v_exp_f32_e64 v4, -v62
    v_mfma_f32_16x16x32_bf16 v[100:103], a[84:87], v[132:135], v[100:103]
    v_mul_f32_e32 v59, v59, v37
    v_mul_f32_e32 v60, v60, v38
    v_mfma_f32_16x16x32_bf16 v[104:107], a[48:51], v[128:131], v[104:107]
    v_fma_f32 v39, v39, s38, s38
    v_fma_f32 v4, v4, s38, s38
    v_mfma_f32_16x16x32_bf16 v[104:107], a[72:75], v[132:135], v[104:107]
    v_rcp_f32_e32 v39, v39
    v_mfma_f32_16x16x32_bf16 v[108:111], a[52:55], v[128:131], v[108:111]
    v_rcp_f32_e32 v4, v4
    v_mfma_f32_16x16x32_bf16 v[108:111], a[76:79], v[132:135], v[108:111]
    s_waitcnt lgkmcnt(0)
    v_mul_f32_e32 v61, v61, v39
    v_mul_f32_e32 v62, v62, v4
    v_mfma_f32_16x16x32_bf16 v[88:91], a[112:115], v[136:139], v[88:91]
    ds_read_b128 v[128:131], v167 offset:512
    v_cvt_pk_bf16_f32 v57, v58, v59
    v_mfma_f32_16x16x32_bf16 v[88:91], a[136:139], v[140:143], v[88:91]
    ds_read_b128 v[132:135], v167 offset:576
    v_cvt_pk_bf16_f32 v58, v60, v61
    v_mfma_f32_16x16x32_bf16 v[92:95], a[116:119], v[136:139], v[92:95]
    v_fma_f32 v63, v63, v147, v159
    v_fma_f32 v64, v64, v148, v152
    v_mfma_f32_16x16x32_bf16 v[92:95], a[140:143], v[140:143], v[92:95]
    v_exp_f32_e64 v5, -v63
    v_mfma_f32_16x16x32_bf16 v[96:99], a[104:107], v[136:139], v[96:99]
    v_exp_f32_e64 v6, -v64
    v_mfma_f32_16x16x32_bf16 v[96:99], a[128:131], v[140:143], v[96:99]
    v_fma_f32 v5, v5, s38, s38
    v_fma_f32 v6, v6, s38, s38
    v_mfma_f32_16x16x32_bf16 v[100:103], a[108:111], v[136:139], v[100:103]
    v_rcp_f32_e32 v5, v5
    v_mfma_f32_16x16x32_bf16 v[100:103], a[132:135], v[140:143], v[100:103]
    v_rcp_f32_e32 v6, v6
    v_mfma_f32_16x16x32_bf16 v[104:107], a[96:99], v[136:139], v[104:107]
    v_mul_f32_e32 v63, v63, v5
    v_mul_f32_e32 v64, v64, v6
    v_mfma_f32_16x16x32_bf16 v[104:107], a[120:123], v[140:143], v[104:107]
    v_cvt_pk_bf16_f32 v59, v62, v63
    v_fma_f32 v65, v65, v144, v156
    v_mfma_f32_16x16x32_bf16 v[108:111], a[100:103], v[136:139], v[108:111]
    v_exp_f32_e64 v7, -v65
    v_mfma_f32_16x16x32_bf16 v[108:111], a[124:127], v[140:143], v[108:111]
    s_waitcnt lgkmcnt(0)
    buffer_store_dwordx4 v[16:19], v162, s[28:31], 0 offen offset:2048 sc0 sc1
    v_mfma_f32_16x16x32_bf16 v[88:91], a[160:163], v[128:131], v[88:91]
    ds_read_b128 v[136:139], v167 offset:640
    v_fma_f32 v7, v7, s38, s38
    v_mfma_f32_16x16x32_bf16 v[88:91], a[184:187], v[132:135], v[88:91]
    ds_read_b128 v[140:143], v167 offset:704
    v_fma_f32 v66, v66, v149, v153
    v_mfma_f32_16x16x32_bf16 v[92:95], a[164:167], v[128:131], v[92:95]
    v_rcp_f32_e32 v7, v7
    v_mfma_f32_16x16x32_bf16 v[92:95], a[188:191], v[132:135], v[92:95]
    v_exp_f32_e64 v163, -v66
    v_mfma_f32_16x16x32_bf16 v[96:99], a[152:155], v[128:131], v[96:99]
    v_mul_f32_e32 v65, v65, v7
    v_fma_f32 v163, v163, s38, s38
    v_mfma_f32_16x16x32_bf16 v[96:99], a[176:179], v[132:135], v[96:99]
    v_rcp_f32_e32 v163, v163
    v_mfma_f32_16x16x32_bf16 v[100:103], a[156:159], v[128:131], v[100:103]
    v_mul_f32_e32 v66, v66, v163
    v_cvt_pk_bf16_f32 v64, v64, v65
    v_mfma_f32_16x16x32_bf16 v[100:103], a[180:183], v[132:135], v[100:103]
    v_fma_f32 v67, v67, v145, v157
    v_fma_f32 v68, v68, v150, v154
    v_mfma_f32_16x16x32_bf16 v[104:107], a[144:147], v[128:131], v[104:107]
    v_exp_f32_e64 v164, -v67
    v_mfma_f32_16x16x32_bf16 v[104:107], a[168:171], v[132:135], v[104:107]
    v_exp_f32_e64 v12, -v68
    v_mfma_f32_16x16x32_bf16 v[108:111], a[148:151], v[128:131], v[108:111]
    v_fma_f32 v164, v164, s38, s38
    v_fma_f32 v12, v12, s38, s38
    v_mfma_f32_16x16x32_bf16 v[108:111], a[172:175], v[132:135], v[108:111]
    s_waitcnt lgkmcnt(0)
    v_rcp_f32_e32 v164, v164
    v_mfma_f32_16x16x32_bf16 v[88:91], a[208:211], v[136:139], v[88:91]
    ds_read_b128 v[128:131], v167 offset:768
    v_mul_f32_e32 v67, v67, v164
    v_mfma_f32_16x16x32_bf16 v[88:91], a[232:235], v[140:143], v[88:91]
    ds_read_b128 v[132:135], v167 offset:832
    v_cvt_pk_bf16_f32 v65, v66, v67
    v_mfma_f32_16x16x32_bf16 v[92:95], a[212:215], v[136:139], v[92:95]
    v_rcp_f32_e32 v12, v12
    v_mfma_f32_16x16x32_bf16 v[92:95], a[236:239], v[140:143], v[92:95]
    v_mul_f32_e32 v68, v68, v12
    v_fma_f32 v69, v69, v146, v158
    v_mfma_f32_16x16x32_bf16 v[96:99], a[200:203], v[136:139], v[96:99]
    v_exp_f32_e64 v28, -v69
    v_mfma_f32_16x16x32_bf16 v[96:99], a[224:227], v[140:143], v[96:99]
    v_fma_f32 v28, v28, s38, s38
    v_fma_f32 v70, v70, v151, v155
    v_mfma_f32_16x16x32_bf16 v[100:103], a[204:207], v[136:139], v[100:103]
    v_rcp_f32_e32 v28, v28
    v_mfma_f32_16x16x32_bf16 v[100:103], a[228:231], v[140:143], v[100:103]
    v_exp_f32_e64 v44, -v70
    v_mfma_f32_16x16x32_bf16 v[104:107], a[192:195], v[136:139], v[104:107]
    buffer_store_dwordx4 v[24:27], v162, s[28:31], 0 offen offset:3072 sc0 sc1
    v_mfma_f32_16x16x32_bf16 v[104:107], a[216:219], v[140:143], v[104:107]
    v_mul_f32_e32 v69, v69, v28
    v_fma_f32 v44, v44, s38, s38
    v_mfma_f32_16x16x32_bf16 v[108:111], a[196:199], v[136:139], v[108:111]
    v_rcp_f32_e32 v44, v44
    v_mfma_f32_16x16x32_bf16 v[108:111], a[220:223], v[140:143], v[108:111]
    s_waitcnt lgkmcnt(0)
    v_mul_f32_e32 v70, v70, v44
    v_cvt_pk_bf16_f32 v66, v68, v69
    v_mfma_f32_16x16x32_bf16 v[88:91], v[168:171], v[128:131], v[88:91]
    ds_read_b128 v[136:139], v167 offset:896
    v_fma_f32 v71, v71, v147, v159
    v_mfma_f32_16x16x32_bf16 v[88:91], v[192:195], v[132:135], v[88:91]
    ds_read_b128 v[140:143], v167 offset:960
    v_fma_f32 v72, v72, v148, v152
    v_mfma_f32_16x16x32_bf16 v[92:95], v[172:175], v[128:131], v[92:95]
    v_exp_f32_e64 v45, -v71
    v_mfma_f32_16x16x32_bf16 v[92:95], v[196:199], v[132:135], v[92:95]
    v_exp_f32_e64 v46, -v72
    v_mfma_f32_16x16x32_bf16 v[96:99], a[248:251], v[128:131], v[96:99]
    v_fma_f32 v45, v45, s38, s38
    v_fma_f32 v46, v46, s38, s38
    v_mfma_f32_16x16x32_bf16 v[96:99], v[184:187], v[132:135], v[96:99]
    v_rcp_f32_e32 v45, v45
    v_mfma_f32_16x16x32_bf16 v[100:103], a[252:255], v[128:131], v[100:103]
    v_rcp_f32_e32 v46, v46
    v_mfma_f32_16x16x32_bf16 v[100:103], v[188:191], v[132:135], v[100:103]
    v_mul_f32_e32 v71, v71, v45
    v_mul_f32_e32 v72, v72, v46
    v_mfma_f32_16x16x32_bf16 v[104:107], a[240:243], v[128:131], v[104:107]
    v_cvt_pk_bf16_f32 v67, v70, v71
    v_fma_f32 v73, v73, v144, v156
    v_mfma_f32_16x16x32_bf16 v[104:107], v[176:179], v[132:135], v[104:107]
    v_exp_f32_e64 v47, -v73
    v_mfma_f32_16x16x32_bf16 v[108:111], a[244:247], v[128:131], v[108:111]
    v_fma_f32 v47, v47, s38, s38
    v_fma_f32 v74, v74, v149, v153
    v_mfma_f32_16x16x32_bf16 v[108:111], v[180:183], v[132:135], v[108:111]
    s_waitcnt lgkmcnt(0)
    v_rcp_f32_e32 v47, v47
    v_mfma_f32_16x16x32_bf16 v[88:91], v[216:219], v[136:139], v[88:91]
    ds_read_b128 v[128:131], v167 offset:4352
    v_mul_f32_e32 v73, v73, v47
    v_mfma_f32_16x16x32_bf16 v[88:91], v[240:243], v[140:143], v[88:91]
    ds_read_b128 v[132:135], v167 offset:4416
    v_cvt_pk_bf16_f32 v72, v72, v73
    v_mfma_f32_16x16x32_bf16 v[92:95], v[220:223], v[136:139], v[92:95]
    v_exp_f32_e64 v29, -v74
    v_mfma_f32_16x16x32_bf16 v[92:95], v[244:247], v[140:143], v[92:95]
    v_fma_f32 v29, v29, s38, s38
    v_fma_f32 v75, v75, v145, v157
    v_mfma_f32_16x16x32_bf16 v[96:99], v[208:211], v[136:139], v[96:99]
    v_rcp_f32_e32 v29, v29
    v_mfma_f32_16x16x32_bf16 v[96:99], v[232:235], v[140:143], v[96:99]
    buffer_store_dwordx4 v[32:35], v162, s[28:31], s39 offen sc0 sc1
    v_mfma_f32_16x16x32_bf16 v[100:103], v[212:215], v[136:139], v[100:103]
    v_exp_f32_e64 v30, -v75
    v_mfma_f32_16x16x32_bf16 v[100:103], v[236:239], v[140:143], v[100:103]
    v_mul_f32_e32 v74, v74, v29
    v_fma_f32 v30, v30, s38, s38
    v_mfma_f32_16x16x32_bf16 v[104:107], v[200:203], v[136:139], v[104:107]
    v_rcp_f32_e32 v30, v30
    v_mfma_f32_16x16x32_bf16 v[104:107], v[224:227], v[140:143], v[104:107]
    v_mul_f32_e32 v75, v75, v30
    v_fma_f32 v76, v76, v150, v154
    v_mfma_f32_16x16x32_bf16 v[108:111], v[204:207], v[136:139], v[108:111]
    v_exp_f32_e64 v31, -v76
    v_mfma_f32_16x16x32_bf16 v[108:111], v[228:231], v[140:143], v[108:111]
    s_waitcnt lgkmcnt(0)
    v_fma_f32 v31, v31, s38, s38
    v_cvt_pk_bf16_f32 v73, v74, v75
    v_mfma_f32_16x16x32_bf16 v[96:99], a[16:19], v[128:131], v[96:99]
    ds_read_b128 v[136:139], v167 offset:4480
    v_fma_f32 v77, v77, v146, v158
    v_mfma_f32_16x16x32_bf16 v[96:99], a[40:43], v[132:135], v[96:99]
    ds_read_b128 v[140:143], v167 offset:4544
    v_fma_f32 v78, v78, v151, v155
    v_mfma_f32_16x16x32_bf16 v[100:103], a[20:23], v[128:131], v[100:103]
    v_rcp_f32_e32 v31, v31
    v_mfma_f32_16x16x32_bf16 v[100:103], a[44:47], v[132:135], v[100:103]
    v_exp_f32_e64 v13, -v77
    v_mfma_f32_16x16x32_bf16 v[104:107], a[8:11], v[128:131], v[104:107]
    v_exp_f32_e64 v20, -v78
    v_mfma_f32_16x16x32_bf16 v[104:107], a[32:35], v[132:135], v[104:107]
    v_mul_f32_e32 v76, v76, v31
    v_fma_f32 v13, v13, s38, s38
    v_mfma_f32_16x16x32_bf16 v[108:111], a[12:15], v[128:131], v[108:111]
    v_rcp_f32_e32 v13, v13
    v_mfma_f32_16x16x32_bf16 v[108:111], a[36:39], v[132:135], v[108:111]
    v_mul_f32_e32 v77, v77, v13
    v_fma_f32 v20, v20, s38, s38
    v_mfma_f32_16x16x32_bf16 v[112:115], a[0:3], v[128:131], v[112:115]
    v_rcp_f32_e32 v20, v20
    v_mfma_f32_16x16x32_bf16 v[112:115], a[24:27], v[132:135], v[112:115]
    v_mul_f32_e32 v78, v78, v20
    v_cvt_pk_bf16_f32 v74, v76, v77
    v_mfma_f32_16x16x32_bf16 v[116:119], a[4:7], v[128:131], v[116:119]
    v_fma_f32 v79, v79, v147, v159
    v_fma_f32 v80, v80, v148, v152
    v_mfma_f32_16x16x32_bf16 v[116:119], a[28:31], v[132:135], v[116:119]
    s_waitcnt lgkmcnt(0)
    v_exp_f32_e64 v21, -v79
    v_mfma_f32_16x16x32_bf16 v[96:99], a[64:67], v[136:139], v[96:99]
    ds_read_b128 v[128:131], v167 offset:4608
    v_fma_f32 v21, v21, s38, s38
    v_mfma_f32_16x16x32_bf16 v[96:99], a[88:91], v[140:143], v[96:99]
    ds_read_b128 v[132:135], v167 offset:4672
    v_fma_f32 v81, v81, v144, v156
    v_mfma_f32_16x16x32_bf16 v[100:103], a[68:71], v[136:139], v[100:103]
L_hop5:
    s_cmp_eq_u32 s54, 1
    s_cbranch_scc1 L_back
    buffer_store_dwordx4 v[40:43], v162, s[28:31], s39 offen offset:1024 sc0 sc1
    v_mfma_f32_16x16x32_bf16 v[100:103], a[92:95], v[140:143], v[100:103]
    v_rcp_f32_e32 v21, v21
    v_mfma_f32_16x16x32_bf16 v[104:107], a[56:59], v[136:139], v[104:107]
    v_exp_f32_e64 v22, -v80
    v_mfma_f32_16x16x32_bf16 v[104:107], a[80:83], v[140:143], v[104:107]
    v_exp_f32_e64 v23, -v81
    v_mfma_f32_16x16x32_bf16 v[108:111], a[60:63], v[136:139], v[108:111]
    v_mul_f32_e32 v79, v79, v21
    v_fma_f32 v22, v22, s38, s38
    v_mfma_f32_16x16x32_bf16 v[108:111], a[84:87], v[140:143], v[108:111]
    v_rcp_f32_e32 v22, v22
    v_mfma_f32_16x16x32_bf16 v[112:115], a[48:51], v[136:139], v[112:115]
    v_cvt_pk_bf16_f32 v75, v78, v79
    v_mul_f32_e32 v80, v80, v22
    v_mfma_f32_16x16x32_bf16 v[112:115], a[72:75], v[140:143], v[112:115]
    v_fma_f32 v23, v23, s38, s38
    v_fma_f32 v82, v82, v149, v153
    v_mfma_f32_16x16x32_bf16 v[116:119], a[52:55], v[136:139], v[116:119]
    v_rcp_f32_e32 v23, v23
    v_mfma_f32_16x16x32_bf16 v[116:119], a[76:79], v[140:143], v[116:119]
    s_waitcnt lgkmcnt(0)
    v_exp_f32_e64 v52, -v82
    v_mfma_f32_16x16x32_bf16 v[96:99], a[112:115], v[128:131], v[96:99]
    ds_read_b128 v[136:139], v167 offset:4736
    v_mul_f32_e32 v81, v81, v23
    v_mfma_f32_16x16x32_bf16 v[96:99], a[136:139], v[132:135], v[96:99]
    ds_read_b128 v[140:143], v167 offset:4800
    v_fma_f32 v52, v52, s38, s38
    v_mfma_f32_16x16x32_bf16 v[100:103], a[116:119], v[128:131], v[100:103]
    v_rcp_f32_e32 v52, v52
    v_mfma_f32_16x16x32_bf16 v[100:103], a[140:143], v[132:135], v[100:103]
    v_mul_f32_e32 v82, v82, v52
    v_cvt_pk_bf16_f32 v80, v80, v81
    v_mfma_f32_16x16x32_bf16 v[104:107], a[104:107], v[128:131], v[104:107]
    v_fma_f32 v83, v83, v145, v157
    v_fma_f32 v84, v84, v150, v154
    v_mfma_f32_16x16x32_bf16 v[104:107], a[128:131], v[132:135], v[104:107]
    v_exp_f32_e64 v53, -v83
    v_mfma_f32_16x16x32_bf16 v[108:111], a[108:111], v[128:131], v[108:111]
    v_exp_f32_e64 v54, -v84
    v_mfma_f32_16x16x32_bf16 v[108:111], a[132:135], v[132:135], v[108:111]
    v_fma_f32 v53, v53, s38, s38
    v_fma_f32 v54, v54, s38, s38
    v_mfma_f32_16x16x32_bf16 v[112:115], a[96:99], v[128:131], v[112:115]
    v_rcp_f32_e32 v53, v53
    v_mfma_f32_16x16x32_bf16 v[112:115], a[120:123], v[132:135], v[112:115]
    v_rcp_f32_e32 v54, v54
    v_mfma_f32_16x16x32_bf16 v[116:119], a[100:103], v[128:131], v[116:119]
    v_mul_f32_e32 v83, v83, v53
    v_mul_f32_e32 v84, v84, v54
    v_mfma_f32_16x16x32_bf16 v[116:119], a[124:127], v[132:135], v[116:119]
    s_waitcnt lgkmcnt(0)
    buffer_store_dwordx4 v[48:51], v162, s[28:31], s39 offen offset:2048 sc0 sc1
    v_mfma_f32_16x16x32_bf16 v[96:99], a[160:163], v[136:139], v[96:99]
    ds_read_b128 v[128:131], v167 offset:4864
    v_cvt_pk_bf16_f32 v81, v82, v83
    v_mfma_f32_16x16x32_bf16 v[96:99], a[184:187], v[140:143], v[96:99]
    ds_read_b128 v[132:135], v167 offset:4928
    v_fma_f32 v85, v85, v146, v158
    v_mfma_f32_16x16x32_bf16 v[100:103], a[164:167], v[136:139], v[100:103]
    v_exp_f32_e64 v55, -v85
    v_mfma_f32_16x16x32_bf16 v[100:103], a[188:191], v[140:143], v[100:103]
    v_fma_f32 v55, v55, s38, s38
    v_fma_f32 v86, v86, v151, v155
    v_mfma_f32_16x16x32_bf16 v[104:107], a[152:155], v[136:139], v[104:107]
    v_rcp_f32_e32 v55, v55
    v_mfma_f32_16x16x32_bf16 v[104:107], a[176:179], v[140:143], v[104:107]
    v_exp_f32_e64 v4, -v86
    v_mfma_f32_16x16x32_bf16 v[108:111], a[156:159], v[136:139], v[108:111]
    v_mul_f32_e32 v85, v85, v55
    v_fma_f32 v4, v4, s38, s38
    v_mfma_f32_16x16x32_bf16 v[108:111], a[180:183], v[140:143], v[108:111]
    v_rcp_f32_e32 v4, v4
    v_mfma_f32_16x16x32_bf16 v[112:115], a[144:147], v[136:139], v[112:115]
    v_mul_f32_e32 v86, v86, v4
    v_cvt_pk_bf16_f32 v82, v84, v85
    v_mfma_f32_16x16x32_bf16 v[112:115], a[168:171], v[140:143], v[112:115]
    ds_read_b128 v[8:11], v167 offset:8576
    v_fma_f32 v87, v87, v147, v159
    v_mfma_f32_16x16x32_bf16 v[116:119], a[148:151], v[136:139], v[116:119]
    v_exp_f32_e64 v5, -v87
    v_mfma_f32_16x16x32_bf16 v[116:119], a[172:175], v[140:143], v[116:119]
    s_waitcnt lgkmcnt(1)
    ds_read_b128 v[12:15], v167 offset:8640
    v_fma_f32 v5, v5, s38, s38
    v_mfma_f32_16x16x32_bf16 v[96:99], a[208:211], v[128:131], v[96:99]
    ds_read_b128 v[136:139], v167 offset:4992
    v_fma_f32 v88, v88, v148, v152
    v_mfma_f32_16x16x32_bf16 v[96:99], a[232:235], v[132:135], v[96:99]
    ds_read_b128 v[140:143], v167 offset:5056
    v_fma_f32 v89, v89, v144, v156
    v_mfma_f32_16x16x32_bf16 v[100:103], a[212:215], v[128:131], v[100:103]
    v_rcp_f32_e32 v5, v5
    v_mfma_f32_16x16x32_bf16 v[100:103], a[236:239], v[132:135], v[100:103]
    v_mul_f32_e32 v87, v87, v5
    v_fma_f32 v90, v90, v149, v153
    v_mfma_f32_16x16x32_bf16 v[104:107], a[200:203], v[128:131], v[104:107]
    ds_read_b128 v[16:19], v167 offset:8704
    v_cvt_pk_bf16_f32 v83, v86, v87
    v_mfma_f32_16x16x32_bf16 v[104:107], a[224:227], v[132:135], v[104:107]
    ds_read_b128 v[20:23], v167 offset:8768
    v_fma_f32 v91, v91, v145, v157
    v_mfma_f32_16x16x32_bf16 v[108:111], a[204:207], v[128:131], v[108:111]
    v_exp_f32_e64 v6, -v88
    v_mfma_f32_16x16x32_bf16 v[108:111], a[228:231], v[132:135], v[108:111]
    v_exp_f32_e64 v60, -v89
    v_mfma_f32_16x16x32_bf16 v[112:115], a[192:195], v[128:131], v[112:115]
    buffer_store_dwordx4 v[56:59], v162, s[28:31], s39 offen offset:3072 sc0 sc1
    v_mfma_f32_16x16x32_bf16 v[112:115], a[216:219], v[132:135], v[112:115]
    v_exp_f32_e64 v61, -v90
    v_mfma_f32_16x16x32_bf16 v[116:119], a[196:199], v[128:131], v[116:119]
    v_exp_f32_e64 v62, -v91
    v_mfma_f32_16x16x32_bf16 v[116:119], a[220:223], v[132:135], v[116:119]
    s_waitcnt lgkmcnt(2)
    v_fma_f32 v6, v6, s38, s38
    v_fma_f32 v60, v60, s38, s38
    v_mfma_f32_16x16x32_bf16 v[96:99], v[168:171], v[136:139], v[96:99]
    ds_read_b128 v[128:131], v167 offset:5120
    v_fma_f32 v61, v61, s38, s38
    v_mfma_f32_16x16x32_bf16 v[96:99], v[192:195], v[140:143], v[96:99]
    ds_read_b128 v[132:135], v167 offset:5184
    v_fma_f32 v62, v62, s38, s38
    v_mfma_f32_16x16x32_bf16 v[100:103], v[172:175], v[136:139], v[100:103]
    ds_read_b128 v[24:27], v167 offset:8832
    v_fma_f32 v92, v92, v150, v154
    v_mfma_f32_16x16x32_bf16 v[100:103], v[196:199], v[140:143], v[100:103]
    ds_read_b128 v[28:31], v167 offset:8896
    v_fma_f32 v93, v93, v146, v158
    v_mfma_f32_16x16x32_bf16 v[104:107], a[248:251], v[136:139], v[104:107]
    v_rcp_f32_e32 v6, v6
    v_mfma_f32_16x16x32_bf16 v[104:107], v[184:187], v[140:143], v[104:107]
    v_rcp_f32_e32 v60, v60
    v_mfma_f32_16x16x32_bf16 v[108:111], a[252:255], v[136:139], v[108:111]
    v_rcp_f32_e32 v61, v61
    v_mfma_f32_16x16x32_bf16 v[108:111], v[188:191], v[140:143], v[108:111]
    v_rcp_f32_e32 v62, v62
    v_mfma_f32_16x16x32_bf16 v[112:115], a[240:243], v[136:139], v[112:115]
    ds_read_b128 v[32:35], v167 offset:8960
    v_mul_f32_e32 v88, v88, v6
    v_mfma_f32_16x16x32_bf16 v[112:115], v[176:179], v[140:143], v[112:115]
    ds_read_b128 v[36:39], v167 offset:9024
    v_mul_f32_e32 v89, v89, v60
    v_mfma_f32_16x16x32_bf16 v[116:119], a[244:247], v[136:139], v[116:119]
    v_exp_f32_e64 v7, -v92
    v_mfma_f32_16x16x32_bf16 v[116:119], v[180:183], v[140:143], v[116:119]
    s_waitcnt lgkmcnt(4)
    v_exp_f32_e64 v163, -v93
    v_mfma_f32_16x16x32_bf16 v[96:99], v[216:219], v[128:131], v[96:99]
    v_mul_f32_e32 v90, v90, v61
    v_mul_f32_e32 v91, v91, v62
    v_mfma_f32_16x16x32_bf16 v[96:99], v[240:243], v[132:135], v[96:99]
    v_fma_f32 v7, v7, s38, s38
    v_fma_f32 v163, v163, s38, s38
    v_mfma_f32_16x16x32_bf16 v[100:103], v[220:223], v[128:131], v[100:103]
    v_rcp_f32_e32 v7, v7
    v_mfma_f32_16x16x32_bf16 v[100:103], v[244:247], v[132:135], v[100:103]
    v_rcp_f32_e32 v163, v163
    v_mfma_f32_16x16x32_bf16 v[104:107], v[208:211], v[128:131], v[104:107]
    ds_read_b128 v[40:43], v167 offset:9088
    v_mul_f32_e32 v92, v92, v7
    v_mfma_f32_16x16x32_bf16 v[104:107], v[232:235], v[132:135], v[104:107]
    buffer_store_dwordx4 v[64:67], v162, s[28:31], s40 offen sc0 sc1
    v_mfma_f32_16x16x32_bf16 v[108:111], v[212:215], v[128:131], v[108:111]
    ds_read_b128 v[44:47], v167 offset:9152
    v_mul_f32_e32 v93, v93, v163
    v_mfma_f32_16x16x32_bf16 v[108:111], v[236:239], v[132:135], v[108:111]
    v_cvt_pk_bf16_f32 v88, v88, v89
    v_cvt_pk_bf16_f32 v89, v90, v91
    v_mfma_f32_16x16x32_bf16 v[112:115], v[200:203], v[128:131], v[112:115]
    v_cvt_pk_bf16_f32 v90, v92, v93
    v_fma_f32 v94, v94, v151, v155
    v_mfma_f32_16x16x32_bf16 v[112:115], v[224:227], v[132:135], v[112:115]
    v_exp_f32_e64 v164, -v94
    v_mfma_f32_16x16x32_bf16 v[116:119], v[204:207], v[128:131], v[116:119]
    v_fma_f32 v164, v164, s38, s38
    v_fma_f32 v95, v95, v147, v159
    v_mfma_f32_16x16x32_bf16 v[116:119], v[228:231], v[132:135], v[116:119]
    v_rcp_f32_e32 v164, v164
    v_mfma_f32_16x16x32_bf16 v[104:107], a[16:19], v[8:11], v[104:107]
    ds_read_b128 v[48:51], v167 offset:9216
    v_mul_f32_e32 v94, v94, v164
    v_mfma_f32_16x16x32_bf16 v[104:107], a[40:43], v[12:15], v[104:107]
    ds_read_b128 v[52:55], v167 offset:9280
    v_fma_f32 v96, v96, v148, v152
    v_mfma_f32_16x16x32_bf16 v[108:111], a[20:23], v[8:11], v[108:111]
    v_exp_f32_e64 v84, -v95
    v_mfma_f32_16x16x32_bf16 v[108:111], a[44:47], v[12:15], v[108:111]
    v_exp_f32_e64 v85, -v96
    v_mfma_f32_16x16x32_bf16 v[112:115], a[8:11], v[8:11], v[112:115]
    v_fma_f32 v84, v84, s38, s38
    v_fma_f32 v85, v85, s38, s38
    v_mfma_f32_16x16x32_bf16 v[112:115], a[32:35], v[12:15], v[112:115]
    v_rcp_f32_e32 v84, v84
    v_mfma_f32_16x16x32_bf16 v[116:119], a[12:15], v[8:11], v[116:119]
    v_rcp_f32_e32 v85, v85
    v_mfma_f32_16x16x32_bf16 v[116:119], a[36:39], v[12:15], v[116:119]
    v_mul_f32_e32 v95, v95, v84
    v_mul_f32_e32 v96, v96, v85
    v_mfma_f32_16x16x32_bf16 v[104:107], a[64:67], v[16:19], v[104:107]
    ds_read_b128 v[56:59], v167 offset:9344
    v_cvt_pk_bf16_f32 v91, v94, v95
    v_mfma_f32_16x16x32_bf16 v[104:107], a[88:91], v[20:23], v[104:107]
    ds_read_b128 v[60:63], v167 offset:9408
    v_fma_f32 v97, v97, v144, v156
    v_mfma_f32_16x16x32_bf16 v[108:111], a[68:71], v[16:19], v[108:111]
    v_exp_f32_e64 v163, -v97
    v_mfma_f32_16x16x32_bf16 v[108:111], a[92:95], v[20:23], v[108:111]
    v_fma_f32 v163, v163, s38, s38
    v_fma_f32 v98, v98, v149, v153
    v_mfma_f32_16x16x32_bf16 v[112:115], a[56:59], v[16:19], v[112:115]
    v_rcp_f32_e32 v163, v163
    v_mfma_f32_16x16x32_bf16 v[112:115], a[80:83], v[20:23], v[112:115]
    v_exp_f32_e64 v164, -v98
    v_mfma_f32_16x16x32_bf16 v[116:119], a[60:63], v[16:19], v[116:119]
    buffer_store_dwordx4 v[72:75], v162, s[28:31], s40 offen offset:1024 sc0 sc1
    v_mfma_f32_16x16x32_bf16 v[116:119], a[84:87], v[20:23], v[116:119]
    s_waitcnt lgkmcnt(8)
    v_mul_f32_e32 v97, v97, v163
    v_fma_f32 v164, v164, s38, s38
    v_mfma_f32_16x16x32_bf16 v[104:107], a[112:115], v[24:27], v[104:107]
    ds_read_b128 v[136:139], v167 offset:12800
    v_cvt_pk_bf16_f32 v96, v96, v97
    v_mfma_f32_16x16x32_bf16 v[104:107], a[136:139], v[28:31], v[104:107]
    ds_read_b128 v[140:143], v167 offset:12864
    v_fma_f32 v99, v99, v145, v157
    v_mfma_f32_16x16x32_bf16 v[108:111], a[116:119], v[24:27], v[108:111]
    v_rcp_f32_e32 v164, v164
    v_mfma_f32_16x16x32_bf16 v[108:111], a[140:143], v[28:31], v[108:111]
    v_exp_f32_e64 v92, -v99
    v_mfma_f32_16x16x32_bf16 v[112:115], a[104:107], v[24:27], v[112:115]
    ds_read_b128 v[128:131], v167 offset:12928
    v_mul_f32_e32 v98, v98, v164
    v_mfma_f32_16x16x32_bf16 v[112:115], a[128:131], v[28:31], v[112:115]
    ds_read_b128 v[132:135], v167 offset:12992
    v_fma_f32 v92, v92, s38, s38
    v_mfma_f32_16x16x32_bf16 v[116:119], a[108:111], v[24:27], v[116:119]
    v_rcp_f32_e32 v92, v92
    v_mfma_f32_16x16x32_bf16 v[116:119], a[132:135], v[28:31], v[116:119]
    s_waitcnt lgkmcnt(10)
    v_mul_f32_e32 v99, v99, v92
    v_fma_f32 v100, v100, v150, v154
    v_mfma_f32_16x16x32_bf16 v[104:107], a[160:163], v[32:35], v[104:107]
    ds_read_b128 v[0:3], v167 offset:13056
    v_cvt_pk_bf16_f32 v97, v98, v99
    v_mfma_f32_16x16x32_bf16 v[104:107], a[184:187], v[36:39], v[104:107]
    ds_read_b128 v[4:7], v167 offset:13120
    v_fma_f32 v101, v101, v146, v158
    v_mfma_f32_16x16x32_bf16 v[108:111], a[164:167], v[32:35], v[108:111]
    v_exp_f32_e64 v93, -v100
    v_mfma_f32_16x16x32_bf16 v[108:111], a[188:191], v[36:39], v[108:111]
    v_exp_f32_e64 v94, -v101
    v_mfma_f32_16x16x32_bf16 v[112:115], a[152:155], v[32:35], v[112:115]
    ds_read_b128 v[64:67], v167 offset:13184
    v_fma_f32 v93, v93, s38, s38
    v_mfma_f32_16x16x32_bf16 v[112:115], a[176:179], v[36:39], v[112:115]
    ds_read_b128 v[68:71], v167 offset:13248
    v_fma_f32 v94, v94, s38, s38
    v_mfma_f32_16x16x32_bf16 v[116:119], a[156:159], v[32:35], v[116:119]
    v_rcp_f32_e32 v93, v93
    v_mfma_f32_16x16x32_bf16 v[116:119], a[180:183], v[36:39], v[116:119]
    s_waitcnt lgkmcnt(12)
    v_rcp_f32_e32 v94, v94
    v_mfma_f32_16x16x32_bf16 v[104:107], a[208:211], v[40:43], v[104:107]
    ds_read_b128 v[72:75], v167 offset:13312
    v_mul_f32_e32 v100, v100, v93
    v_mfma_f32_16x16x32_bf16 v[104:107], a[232:235], v[44:47], v[104:107]
    ds_read_b128 v[76:79], v167 offset:13376
    v_mul_f32_e32 v101, v101, v94
    v_mfma_f32_16x16x32_bf16 v[108:111], a[212:215], v[40:43], v[108:111]
    v_cvt_pk_bf16_f32 v98, v100, v101
    v_fma_f32 v102, v102, v151, v155
    v_mfma_f32_16x16x32_bf16 v[108:111], a[236:239], v[44:47], v[108:111]
    buffer_store_dwordx4 v[80:83], v162, s[28:31], s40 offen offset:2048 sc0 sc1
    v_mfma_f32_16x16x32_bf16 v[112:115], a[200:203], v[40:43], v[112:115]
    v_exp_f32_e64 v95, -v102
    v_mfma_f32_16x16x32_bf16 v[112:115], a[224:227], v[44:47], v[112:115]
    ds_read_b128 v[80:83], v167 offset:13440
    v_fma_f32 v95, v95, s38, s38
    v_mfma_f32_16x16x32_bf16 v[116:119], a[204:207], v[40:43], v[116:119]
    ds_read_b128 v[84:87], v167 offset:13504
    v_fma_f32 v103, v103, v147, v159
    v_mfma_f32_16x16x32_bf16 v[116:119], a[228:231], v[44:47], v[116:119]
    s_waitcnt lgkmcnt(14)
    v_rcp_f32_e32 v95, v95
    v_mfma_f32_16x16x32_bf16 v[104:107], v[168:171], v[48:51], v[104:107]
    v_exp_f32_e64 v163, -v103
    v_mfma_f32_16x16x32_bf16 v[104:107], v[192:195], v[52:55], v[104:107]
    v_mul_f32_e32 v102, v102, v95
    v_fma_f32 v163, v163, s38, s38
    v_mfma_f32_16x16x32_bf16 v[108:111], v[172:175], v[48:51], v[108:111]
    v_rcp_f32_e32 v163, v163
    v_mfma_f32_16x16x32_bf16 v[108:111], v[196:199], v[52:55], v[108:111]
    v_mul_f32_e32 v103, v103, v163
    v_mfma_f32_16x16x32_bf16 v[112:115], a[248:251], v[48:51], v[112:115]
    v_cvt_pk_bf16_f32 v99, v102, v103
    v_mfma_f32_16x16x32_bf16 v[112:115], v[184:187], v[52:55], v[112:115]
    v_mfma_f32_16x16x32_bf16 v[116:119], a[252:255], v[48:51], v[116:119]
    v_mfma_f32_16x16x32_bf16 v[116:119], v[188:191], v[52:55], v[116:119]
    s_waitcnt lgkmcnt(12)
    v_mfma_f32_16x16x32_bf16 v[104:107], v[216:219], v[56:59], v[104:107]
    v_mfma_f32_16x16x32_bf16 v[104:107], v[240:243], v[60:63], v[104:107]
    v_mfma_f32_16x16x32_bf16 v[108:111], v[220:223], v[56:59], v[108:111]
    v_mfma_f32_16x16x32_bf16 v[108:111], v[244:247], v[60:63], v[108:111]
    v_mfma_f32_16x16x32_bf16 v[112:115], v[208:211], v[56:59], v[112:115]
    v_mfma_f32_16x16x32_bf16 v[112:115], v[232:235], v[60:63], v[112:115]
    v_mfma_f32_16x16x32_bf16 v[116:119], v[212:215], v[56:59], v[116:119]
    v_mfma_f32_16x16x32_bf16 v[116:119], v[236:239], v[60:63], v[116:119]
    s_waitcnt lgkmcnt(10)
    v_mfma_f32_16x16x32_bf16 v[112:115], a[16:19], v[136:139], v[112:115]
    ds_read_b128 a[16:19], v167 offset:13568
    v_mfma_f32_16x16x32_bf16 v[112:115], a[40:43], v[140:143], v[112:115]
    ds_read_b128 a[40:43], v167 offset:13632
    v_mfma_f32_16x16x32_bf16 v[116:119], a[20:23], v[136:139], v[116:119]
    buffer_store_dwordx4 v[88:91], v162, s[28:31], s40 offen offset:3072 sc0 sc1
    v_mfma_f32_16x16x32_bf16 v[116:119], a[44:47], v[140:143], v[116:119]
    s_waitcnt lgkmcnt(10)
    v_fma_f32 v104, v104, v148, v152
    v_fma_f32 v105, v105, v144, v156
    v_mfma_f32_16x16x32_bf16 v[112:115], a[64:67], v[128:131], v[112:115]
    v_exp_f32_e64 v164, -v104
    v_mfma_f32_16x16x32_bf16 v[112:115], a[88:91], v[132:135], v[112:115]
    v_exp_f32_e64 v92, -v105
    v_mfma_f32_16x16x32_bf16 v[116:119], a[68:71], v[128:131], v[116:119]
    v_fma_f32 v164, v164, s38, s38
    v_fma_f32 v92, v92, s38, s38
    v_mfma_f32_16x16x32_bf16 v[116:119], a[92:95], v[132:135], v[116:119]
    s_waitcnt lgkmcnt(8)
    v_rcp_f32_e32 v164, v164
    v_mfma_f32_16x16x32_bf16 v[112:115], a[112:115], v[0:3], v[112:115]
    v_rcp_f32_e32 v92, v92
    v_mfma_f32_16x16x32_bf16 v[112:115], a[136:139], v[4:7], v[112:115]
    v_mul_f32_e32 v104, v104, v164
    v_mul_f32_e32 v105, v105, v92
    v_mfma_f32_16x16x32_bf16 v[116:119], a[116:119], v[0:3], v[116:119]
    v_cvt_pk_bf16_f32 v104, v104, v105
    v_fma_f32 v106, v106, v149, v153
    v_mfma_f32_16x16x32_bf16 v[116:119], a[140:143], v[4:7], v[116:119]
    s_waitcnt lgkmcnt(6)
    v_exp_f32_e64 v93, -v106
    v_mfma_f32_16x16x32_bf16 v[112:115], a[160:163], v[64:67], v[112:115]
    v_fma_f32 v93, v93, s38, s38
    v_fma_f32 v107, v107, v145, v157
    v_mfma_f32_16x16x32_bf16 v[112:115], a[184:187], v[68:71], v[112:115]
    v_rcp_f32_e32 v93, v93
    v_mfma_f32_16x16x32_bf16 v[116:119], a[164:167], v[64:67], v[116:119]
    v_exp_f32_e64 v94, -v107
    v_mfma_f32_16x16x32_bf16 v[116:119], a[188:191], v[68:71], v[116:119]
    s_waitcnt lgkmcnt(4)
    v_mul_f32_e32 v106, v106, v93
    v_fma_f32 v94, v94, s38, s38
    v_mfma_f32_16x16x32_bf16 v[112:115], a[208:211], v[72:75], v[112:115]
    v_rcp_f32_e32 v94, v94
    v_mfma_f32_16x16x32_bf16 v[112:115], a[232:235], v[76:79], v[112:115]
    v_mul_f32_e32 v107, v107, v94
    v_fma_f32 v108, v108, v150, v154
    v_mfma_f32_16x16x32_bf16 v[116:119], a[212:215], v[72:75], v[116:119]
    v_exp_f32_e64 v95, -v108
    v_mfma_f32_16x16x32_bf16 v[116:119], a[236:239], v[76:79], v[116:119]
    s_waitcnt lgkmcnt(2)
    v_fma_f32 v95, v95, s38, s38
    v_cvt_pk_bf16_f32 v105, v106, v107
    v_mfma_f32_16x16x32_bf16 v[112:115], v[168:171], v[80:83], v[112:115]
    v_rcp_f32_e32 v95, v95
    v_mfma_f32_16x16x32_bf16 v[112:115], v[192:195], v[84:87], v[112:115]
    v_mul_f32_e32 v108, v108, v95
    v_fma_f32 v109, v109, v146, v158
    v_mfma_f32_16x16x32_bf16 v[116:119], v[172:175], v[80:83], v[116:119]
    v_exp_f32_e64 v163, -v109
    v_mfma_f32_16x16x32_bf16 v[116:119], v[196:199], v[84:87], v[116:119]
    s_waitcnt lgkmcnt(0)
    buffer_store_dwordx4 v[96:99], v162, s[28:31], s41 offen sc0 sc1
    v_mfma_f32_16x16x32_bf16 v[112:115], v[216:219], a[16:19], v[112:115]
    v_fma_f32 v163, v163, s38, s38
    v_fma_f32 v110, v110, v151, v155
    v_mfma_f32_16x16x32_bf16 v[112:115], v[240:243], a[40:43], v[112:115]
    v_rcp_f32_e32 v163, v163
    v_mfma_f32_16x16x32_bf16 v[116:119], v[220:223], a[16:19], v[116:119]
    v_exp_f32_e64 v100, -v110
    v_mfma_f32_16x16x32_bf16 v[116:119], v[244:247], a[40:43], v[116:119]
    v_mul_f32_e32 v109, v109, v163
    v_fma_f32 v100, v100, s38, s38
    v_mfma_f32_16x16x32_bf16 v[120:123], a[8:11], v[136:139], v[120:123]
    v_rcp_f32_e32 v100, v100
    v_mfma_f32_16x16x32_bf16 v[120:123], a[32:35], v[140:143], v[120:123]
    v_mul_f32_e32 v110, v110, v100
    v_cvt_pk_bf16_f32 v106, v108, v109
    v_mfma_f32_16x16x32_bf16 v[120:123], a[56:59], v[128:131], v[120:123]
    v_fma_f32 v111, v111, v147, v159
    v_mfma_f32_16x16x32_bf16 v[120:123], a[80:83], v[132:135], v[120:123]
    v_exp_f32_e64 v101, -v111
    v_mfma_f32_16x16x32_bf16 v[120:123], a[104:107], v[0:3], v[120:123]
    v_fma_f32 v101, v101, s38, s38
    v_mfma_f32_16x16x32_bf16 v[120:123], a[128:131], v[4:7], v[120:123]
    v_rcp_f32_e32 v101, v101
    v_mfma_f32_16x16x32_bf16 v[120:123], a[152:155], v[64:67], v[120:123]
    v_mul_f32_e32 v111, v111, v101
    v_fma_f32 v112, v112, v148, v152
    v_mfma_f32_16x16x32_bf16 v[120:123], a[176:179], v[68:71], v[120:123]
    v_exp_f32_e64 v102, -v112
    v_mfma_f32_16x16x32_bf16 v[120:123], a[200:203], v[72:75], v[120:123]
    v_cvt_pk_bf16_f32 v107, v110, v111
    v_fma_f32 v102, v102, s38, s38
    v_mfma_f32_16x16x32_bf16 v[120:123], a[224:227], v[76:79], v[120:123]
    v_rcp_f32_e32 v102, v102
    v_mfma_f32_16x16x32_bf16 v[120:123], a[248:251], v[80:83], v[120:123]
    v_mul_f32_e32 v112, v112, v102
    v_fma_f32 v113, v113, v144, v156
    v_mfma_f32_16x16x32_bf16 v[120:123], v[184:187], v[84:87], v[120:123]
    v_exp_f32_e64 v103, -v113
    v_mfma_f32_16x16x32_bf16 v[120:123], v[208:211], a[16:19], v[120:123]
    v_fma_f32 v103, v103, s38, s38
    v_fma_f32 v114, v114, v149, v153
    v_mfma_f32_16x16x32_bf16 v[120:123], v[232:235], a[40:43], v[120:123]
    v_rcp_f32_e32 v103, v103
    v_mfma_f32_16x16x32_bf16 v[120:123], a[0:3], v[8:11], v[120:123]
    v_exp_f32_e64 v164, -v114
    v_mfma_f32_16x16x32_bf16 v[120:123], a[24:27], v[12:15], v[120:123]
    v_mul_f32_e32 v113, v113, v103
    v_fma_f32 v164, v164, s38, s38
    v_mfma_f32_16x16x32_bf16 v[120:123], a[48:51], v[16:19], v[120:123]
    buffer_store_dwordx4 v[104:107], v162, s[28:31], s41 offen offset:1024 sc0 sc1
    v_mfma_f32_16x16x32_bf16 v[120:123], a[72:75], v[20:23], v[120:123]
    v_rcp_f32_e32 v164, v164
    v_mfma_f32_16x16x32_bf16 v[120:123], a[96:99], v[24:27], v[120:123]
    v_mul_f32_e32 v114, v114, v164
    v_cvt_pk_bf16_f32 v112, v112, v113
    v_mfma_f32_16x16x32_bf16 v[120:123], a[120:123], v[28:31], v[120:123]
    v_fma_f32 v115, v115, v145, v157
    v_fma_f32 v116, v116, v150, v154
    v_mfma_f32_16x16x32_bf16 v[120:123], a[144:147], v[32:35], v[120:123]
    v_exp_f32_e64 v92, -v115
    v_mfma_f32_16x16x32_bf16 v[120:123], a[168:171], v[36:39], v[120:123]
    v_exp_f32_e64 v93, -v116
    v_mfma_f32_16x16x32_bf16 v[120:123], a[192:195], v[40:43], v[120:123]
    v_fma_f32 v92, v92, s38, s38
    v_fma_f32 v93, v93, s38, s38
    v_mfma_f32_16x16x32_bf16 v[120:123], a[216:219], v[44:47], v[120:123]
    v_rcp_f32_e32 v92, v92
    v_mfma_f32_16x16x32_bf16 v[120:123], a[240:243], v[48:51], v[120:123]
    v_rcp_f32_e32 v93, v93
    v_mfma_f32_16x16x32_bf16 v[120:123], v[176:179], v[52:55], v[120:123]
    v_mul_f32_e32 v115, v115, v92
    v_mul_f32_e32 v116, v116, v93
    v_mfma_f32_16x16x32_bf16 v[120:123], v[200:203], v[56:59], v[120:123]
    v_cvt_pk_bf16_f32 v113, v114, v115
    v_fma_f32 v117, v117, v146, v158
    v_mfma_f32_16x16x32_bf16 v[120:123], v[224:227], v[60:63], v[120:123]
    v_exp_f32_e64 v94, -v117
    v_mfma_f32_16x16x32_bf16 v[124:127], a[12:15], v[136:139], v[124:127]
    v_fma_f32 v94, v94, s38, s38
    v_fma_f32 v118, v118, v151, v155
    v_mfma_f32_16x16x32_bf16 v[124:127], a[36:39], v[140:143], v[124:127]
    v_rcp_f32_e32 v94, v94
    v_mfma_f32_16x16x32_bf16 v[124:127], a[60:63], v[128:131], v[124:127]
    v_exp_f32_e64 v95, -v118
    v_mfma_f32_16x16x32_bf16 v[124:127], a[84:87], v[132:135], v[124:127]
    v_mul_f32_e32 v117, v117, v94
    v_fma_f32 v95, v95, s38, s38
    v_mfma_f32_16x16x32_bf16 v[124:127], a[108:111], v[0:3], v[124:127]
    v_rcp_f32_e32 v95, v95
    v_mfma_f32_16x16x32_bf16 v[124:127], a[132:135], v[4:7], v[124:127]
    v_mul_f32_e32 v118, v118, v95
    v_cvt_pk_bf16_f32 v114, v116, v117
    v_mfma_f32_16x16x32_bf16 v[124:127], a[156:159], v[64:67], v[124:127]
    v_fma_f32 v119, v119, v147, v159
    v_mfma_f32_16x16x32_bf16 v[124:127], a[180:183], v[68:71], v[124:127]
    v_exp_f32_e64 v163, -v119
    v_mfma_f32_16x16x32_bf16 v[124:127], a[204:207], v[72:75], v[124:127]
    v_fma_f32 v163, v163, s38, s38
    v_fma_f32 v120, v120, v148, v152
    v_mfma_f32_16x16x32_bf16 v[124:127], a[228:231], v[76:79], v[124:127]
    v_rcp_f32_e32 v163, v163
    v_mfma_f32_16x16x32_bf16 v[124:127], a[252:255], v[80:83], v[124:127]
    v_exp_f32_e64 v100, -v120
    v_mfma_f32_16x16x32_bf16 v[124:127], v[188:191], v[84:87], v[124:127]
    v_mul_f32_e32 v119, v119, v163
    v_fma_f32 v100, v100, s38, s38
    v_mfma_f32_16x16x32_bf16 v[124:127], v[212:215], a[16:19], v[124:127]
    v_rcp_f32_e32 v100, v100
    v_mfma_f32_16x16x32_bf16 v[124:127], v[236:239], a[40:43], v[124:127]
    v_cvt_pk_bf16_f32 v115, v118, v119
    v_mul_f32_e32 v120, v120, v100
    v_mfma_f32_16x16x32_bf16 v[124:127], a[4:7], v[8:11], v[124:127]
    buffer_store_dwordx4 v[112:115], v162, s[28:31], s41 offen offset:2048 sc0 sc1
    v_mfma_f32_16x16x32_bf16 v[124:127], a[28:31], v[12:15], v[124:127]
    v_fma_f32 v121, v121, v144, v156
    v_fma_f32 v122, v122, v149, v153
    v_mfma_f32_16x16x32_bf16 v[124:127], a[52:55], v[16:19], v[124:127]
    v_exp_f32_e64 v101, -v121
    v_mfma_f32_16x16x32_bf16 v[124:127], a[76:79], v[20:23], v[124:127]
    v_exp_f32_e64 v108, -v122
    v_mfma_f32_16x16x32_bf16 v[124:127], a[100:103], v[24:27], v[124:127]
    v_fma_f32 v101, v101, s38, s38
    v_fma_f32 v108, v108, s38, s38
    v_mfma_f32_16x16x32_bf16 v[124:127], a[124:127], v[28:31], v[124:127]
    v_rcp_f32_e32 v101, v101
    v_mfma_f32_16x16x32_bf16 v[124:127], a[148:151], v[32:35], v[124:127]
    v_rcp_f32_e32 v108, v108
    v_mfma_f32_16x16x32_bf16 v[124:127], a[172:175], v[36:39], v[124:127]
    v_mul_f32_e32 v121, v121, v101
    v_mul_f32_e32 v122, v122, v108
    v_mfma_f32_16x16x32_bf16 v[124:127], a[196:199], v[40:43], v[124:127]
    v_cvt_pk_bf16_f32 v120, v120, v121
    v_fma_f32 v123, v123, v145, v157
    v_mfma_f32_16x16x32_bf16 v[124:127], a[220:223], v[44:47], v[124:127]
    v_exp_f32_e64 v109, -v123
    v_mfma_f32_16x16x32_bf16 v[124:127], a[244:247], v[48:51], v[124:127]
    v_fma_f32 v109, v109, s38, s38
    v_mfma_f32_16x16x32_bf16 v[124:127], v[180:183], v[52:55], v[124:127]
    v_rcp_f32_e32 v109, v109
    v_mfma_f32_16x16x32_bf16 v[124:127], v[204:207], v[56:59], v[124:127]
    v_mul_f32_e32 v123, v123, v109
    v_mfma_f32_16x16x32_bf16 v[124:127], v[228:231], v[60:63], v[124:127]
    v_cvt_pk_bf16_f32 v121, v122, v123
    s_nop 6
    v_fma_f32 v124, v124, v150, v154
    v_fma_f32 v125, v125, v146, v158
    v_fma_f32 v126, v126, v151, v155
    v_fma_f32 v127, v127, v147, v159
    v_exp_f32_e64 v110, -v124
    v_exp_f32_e64 v111, -v125
    v_exp_f32_e64 v102, -v126
    v_exp_f32_e64 v103, -v127
    v_fma_f32 v110, v110, s38, s38
    v_fma_f32 v111, v111, s38, s38
    v_fma_f32 v102, v102, s38, s38
    v_fma_f32 v103, v103, s38, s38
    v_rcp_f32_e32 v110, v110
    v_rcp_f32_e32 v111, v111
    v_rcp_f32_e32 v102, v102
    v_rcp_f32_e32 v103, v103
    v_mul_f32_e32 v124, v124, v110
    v_mul_f32_e32 v125, v125, v111
    v_mul_f32_e32 v126, v126, v102
    v_mul_f32_e32 v127, v127, v103
    v_cvt_pk_bf16_f32 v122, v124, v125
    v_cvt_pk_bf16_f32 v123, v126, v127
    buffer_store_dwordx4 v[120:123], v162, s[28:31], s41 offen offset:3072 sc0 sc1
L_end:
    s_endpgm
L_hop6:
L_hop7:
    s_branch L_back
.section .rodata,"a"
.p2align 6
.amdhsa_kernel standalone__batchnorm__sampling_kernel
  .amdhsa_next_free_vgpr 512
  .amdhsa_next_free_sgpr 102
  .amdhsa_accum_offset 256
  .amdhsa_group_segment_fixed_size 0
  .amdhsa_kernarg_size 72
  .amdhsa_user_sgpr_count 2
  .amdhsa_user_sgpr_kernarg_segment_ptr 1
  .amdhsa_system_sgpr_workgroup_id_x 1
.end_amdhsa_kernel
```
